```python
import torch

def _softmax(x, axis=-1):
    return torch.softmax(x, dim=axis)
def _gelu(x):
    return torch.nn.functional.gelu(x, approximate="tanh")
def _silu(x):
    return torch.nn.functional.silu(x)
def _sigmoid(x):
    return torch.sigmoid(x)
def _layernorm(x, axis=-1, eps=1e-5):
    m = x.mean(dim=axis, keepdim=True)
    v = x.var(dim=axis, keepdim=True, unbiased=False)
    return (x - m) / torch.sqrt(v + eps)
def _scatter_add(tgt, idx, src, axis=0):
    return tgt.clone().index_add_(axis, idx, src)
def _segment_sum(src, seg, n):
    out = torch.zeros((n,) + src.shape[1:], dtype=src.dtype)
    return out.index_add_(0, seg, src)
def _pad(x, pw):
    flat = tuple(v for pair in reversed(pw) for v in pair)
    return torch.nn.functional.pad(x, flat)

kernel_name = 'gated_mix__ssm_conv_s5__dense_activation_relu__prompt'

def setup_inputs():

    _w = (lambda a: (lambda t: t.to(torch.bfloat16) if t.is_floating_point() else t)(torch.as_tensor(a)))
    def _A_setup():
        B, S, D = 1, 2048, 448
        P = D
        Lambda_re = -0.5 * (lambda _x: torch.exp(torch.as_tensor(_x)))((lambda *s: torch.randn(*s, dtype=torch.bfloat16) * 0.8)(P))
        Lambda_im = (lambda *s: torch.randn(*s, dtype=torch.bfloat16) * 0.8)(P) * 1.0
        B_re = (lambda *s: torch.randn(*s, dtype=torch.bfloat16) * 0.8)(P, D) * (D ** -0.5)
        B_im = (lambda *s: torch.randn(*s, dtype=torch.bfloat16) * 0.8)(P, D) * (D ** -0.5)
        C_re = (lambda *s: torch.randn(*s, dtype=torch.bfloat16) * 0.8)(D, P) * (P ** -0.5)
        C_im = (lambda *s: torch.randn(*s, dtype=torch.bfloat16) * 0.8)(D, P) * (P ** -0.5)
        log_dt = (lambda *s: torch.randn(*s, dtype=torch.bfloat16) * 0.8)(P) * 0.3 - 2.0
        Dskip = (lambda *s: torch.randn(*s, dtype=torch.bfloat16) * 0.8)(D)
        return {
            "x": _w((lambda *s: torch.randn(*s, dtype=torch.bfloat16) * 0.05)(B, S, D)),
            "Lambda_re": _w(Lambda_re),
            "Lambda_im": _w(Lambda_im),
            "B_re": _w(B_re),
            "B_im": _w(B_im),
            "C_re": _w(C_re),
            "C_im": _w(C_im),
            "log_dt": _w(log_dt),
            "Dskip": _w(Dskip),
        }
    _A_in = _A_setup()

    def _B_setup():
        B, S, D, Dff = 1, 2048, 448, 1792
        return {
            "x": _w((lambda *s: torch.randn(*s, dtype=torch.bfloat16) * 0.05)(B, S, D)),
            "w1": _w((lambda *s: torch.randn(*s, dtype=torch.bfloat16) * 0.05)(D, Dff)),
            "w2": _w((lambda *s: torch.randn(*s, dtype=torch.bfloat16) * 0.05)(Dff, D)),
        }
    _B_in = _B_setup()

    return {
        "A_x": _A_in["x"],
        "A_Lambda_re": _A_in["Lambda_re"],
        "A_Lambda_im": _A_in["Lambda_im"],
        "A_B_re": _A_in["B_re"],
        "A_B_im": _A_in["B_im"],
        "A_C_re": _A_in["C_re"],
        "A_C_im": _A_in["C_im"],
        "A_log_dt": _A_in["log_dt"],
        "A_Dskip": _A_in["Dskip"],
        "B_x": _B_in["x"],
        "B_w1": _B_in["w1"],
        "B_w2": _B_in["w2"],
        "gate_w": _w((lambda *s: torch.randn(*s, dtype=torch.bfloat16) * 0.05)(448) * 16.0),
    }

def reference(A_x, A_Lambda_re, A_Lambda_im, A_B_re, A_B_im, A_C_re, A_C_im, A_log_dt, A_Dskip, B_x, B_w1, B_w2, gate_w):
    def _A_ref(x, Lambda_re, Lambda_im, B_re, B_im, C_re, C_im, log_dt, Dskip):
        Bsz, L, H = x.shape
        Lam = Lambda_re + 1j * Lambda_im
        Bmat = B_re + 1j * B_im
        Cmat = C_re + 1j * C_im
        dt = torch.exp(log_dt)
        Lam_bar = torch.exp(dt * Lam)
        B_bar = ((Lam_bar - 1.0) / Lam)[:, None] * Bmat
        Bu = torch.einsum("bld,pd->blp", x + 0j, B_bar)
        h = torch.zeros_like(Bu[:, 0, :])
        hs = []
        for t in range(L):
            h = Lam_bar[None, :] * h + Bu[:, t, :]
            hs.append(h)
        hseq = torch.stack(hs, 1)
        y = 2.0 * torch.einsum("blp,dp->bld", hseq, Cmat).real + x * Dskip[None, None, :]
        return y

    def _B_ref(x, w1, w2):
        h = torch.einsum("bsd,df->bsf", x, w1)
        zero = torch.zeros_like(h)
        h = torch.maximum(h, zero)
        return torch.einsum("bsf,fd->bsd", h, w2)

    x = A_x
    g = _sigmoid((x * gate_w).sum(-1, keepdims=True))
    a = _A_ref(x, A_Lambda_re, A_Lambda_im, A_B_re, A_B_im, A_C_re, A_C_im, A_log_dt, A_Dskip)
    b = _B_ref(x, B_w1, B_w2)
    return g * a + (1 - g) * b
```

```asm
; @launch grid=(256,1,1) block=(256,1,1) lds=163840
.amdgcn_target "amdgcn-amd-amdhsa--gfx950"
.text
.globl gated_mix__ssm_conv_s5__dense_activation_relu__prompt_kernel
.p2align 12
.p2align 8
.type gated_mix__ssm_conv_s5__dense_activation_relu__prompt_kernel,@function
gated_mix__ssm_conv_s5__dense_activation_relu__prompt_kernel:
    s_load_dwordx2 s[4:5], s[0:1], 0
    s_load_dwordx4 s[32:35], s[0:1], 24
    v_readfirstlane_b32 s3, v0
    s_lshr_b32 s63, s2, 5
    s_sub_u32 s63, s63, 1
    s_cmp_ge_u32 s63, 7
    s_cbranch_scc1 L_helper
    s_lshr_b32 s3, s3, 6
    s_bfe_u32 s69, s2, 0x20003
    s_bfe_u32 s72, s2, 0x20001
    s_lshl2_add_u32 s62, s72, s69
    s_and_b32 s64, s2, 1
    s_lshl1_add_u32 s72, s64, 2
    s_add_u32 s72, s72, s3
    s_and_b32 s66, s72, 3
    s_lshl2_add_u32 s72, s62, s66
    s_lshl_b32 s72, s72, 5
    v_bfe_u32 v153, v0, 4, 2
    v_and_b32 v151, 7, v0
    v_or_b32 v156, s72, v153
    v_xor_b32 v154, v151, v153
    v_and_or_b32 v156, v0, 8, v156
    v_mad_u32_u24 v156, v156, 56, v154
    s_sub_u32 s72, s63, s69
    s_cselect_b32 s74, 7, 0
    s_add_u32 s72, s72, s74
    s_lshl_b32 s48, s72, 7
    s_lshl_b32 s70, s3, 12
    v_lshlrev_b32 v100, 4, v156
    s_mov_b32 s6, 1835008
    s_mov_b32 s7, 0x20000
    s_add_u32 m0, s70, 0
    s_movk_i32 s74, 13312
    s_waitcnt lgkmcnt(0)
    buffer_load_dwordx4 v100, s[4:7], s48 offen offset:0 lds
    v_xad_u32 v101, v100, 64, s74
    buffer_load_dwordx4 v101, s[4:7], s48 offen offset:1024 lds
    v_add_u32 v102, 1536, v100
    s_lshl_b32 s71, s3, 11
    buffer_load_dwordx4 v102, s[4:7], s48 offen offset:2048 lds
    v_add_u32 v103, 1536, v101
    buffer_load_dwordx4 v103, s[4:7], s48 offen offset:3072 lds
    s_add_u32 m0, s71, 16384
    s_mul_i32 s65, s64, 7
    s_add_u32 s65, s65, s63
    s_and_b32 s67, s3, 1
    s_lshl1_add_u32 s72, s65, s67
    s_lshl_b32 s72, s72, 4
    v_bfe_u32 v152, v0, 3, 3
    v_add_u32 v156, s72, v152
    v_mad_u32_u24 v156, v156, 56, v154
    s_lshr_b32 s68, s3, 1
    s_cselect_b32 s8, s34, s32
    s_cselect_b32 s9, s35, s33
    s_mov_b32 s10, 401408
    s_mov_b32 s11, 0x20000
    v_lshlrev_b32 v104, 4, v156
    s_movk_i32 s74, 6144
    buffer_load_dwordx4 v104, s[8:11], s48 offen offset:0 lds
    v_xad_u32 v105, v104, 64, s74
    buffer_load_dwordx4 v105, s[8:11], s48 offen offset:1024 lds
    s_add_u32 m0, s71, 40960
    s_load_dwordx2 s[24:25], s[0:1], 120
    s_load_dwordx4 s[36:39], s[0:1], 8
    s_load_dwordx4 s[40:43], s[0:1], 56
    v_and_b32 v206, 63, v0
    v_lshrrev_b32 v208, 5, v206
    v_lshlrev_b32 v154, 4, v154
    v_xor_b32 v155, 64, v154
    s_add_u32 s73, s48, 128
    s_cmp_lt_u32 s73, 896
    s_cselect_b32 s49, s73, 0
    buffer_load_dwordx4 v104, s[8:11], s49 offen offset:0 lds
    buffer_load_dwordx4 v105, s[8:11], s49 offen offset:1024 lds
    s_add_u32 m0, s70, 24576
    s_lshl_b32 s72, s68, 4
    v_and_or_b32 v207, v206, 15, s72
    s_lshl_b32 s72, s65, 6
    v_lshl_add_u32 v157, v207, 1, s72
    s_lshl_b32 s72, s63, 7
    v_lshl_add_u32 v159, v151, 3, s72
    s_lshl_b32 s72, s67, 3
    s_add_u32 s72, s72, 40
    s_load_dwordx2 s[20:21], s[0:1], s72
    s_load_dwordx2 s[12:13], s[0:1], 80
    s_load_dwordx2 s[16:17], s[0:1], 88
    s_load_dwordx2 s[46:47], s[0:1], 112
    s_add_u32 s72, s49, 128
    s_cmp_lt_u32 s72, 896
    s_cselect_b32 s50, s72, 0
    s_add_u32 s72, s50, 128
    s_cmp_lt_u32 s72, 896
    s_cselect_b32 s51, s72, 0
    s_add_u32 s72, s51, 128
    s_cmp_lt_u32 s72, 896
    s_cselect_b32 s52, s72, 0
    s_add_u32 s72, s52, 128
    s_cmp_lt_u32 s72, 896
    s_cselect_b32 s53, s72, 0
    s_add_u32 s72, s53, 128
    s_cmp_lt_u32 s72, 896
    s_cselect_b32 s54, s72, 0
    s_branch L_cont
L_helper:
    s_cmp_ge_u32 s2, 32
    s_cbranch_scc1 L_end
    s_lshr_b32 s3, s3, 6
    v_and_b32 v206, 63, v0
    s_load_dwordx2 s[24:25], s[0:1], 120
    s_load_dwordx2 s[12:13], s[0:1], 80
    s_load_dwordx2 s[16:17], s[0:1], 88
    s_load_dwordx2 s[20:21], s[0:1], 40
    s_load_dwordx2 s[8:9], s[0:1], 48
    s_getpc_b64 s[28:29]
L_pc0:
    s_sub_u32 s28, s28, L_pc0-gated_mix__ssm_conv_s5__dense_activation_relu__prompt_kernel
    s_subb_u32 s29, s29, 0
    v_lshlrev_b32 v148, 7, v0
    v_min_u32 v149, L_end-gated_mix__ssm_conv_s5__dense_activation_relu__prompt_kernel, v148
    global_load_dword v150, v149, s[28:29]
    s_and_b32 s82, s2, 1
    s_bfe_u32 s83, s2, 0x20001
    s_lshr_b32 s84, s2, 3
    s_lshl2_add_u32 s81, s83, s84
    s_lshl1_add_u32 s81, s81, s82
    s_lshl_b32 s84, s84, 2
    s_lshl_b32 s85, s2, 12
    v_lshl_add_u32 v152, v0, 4, s85
    v_mov_b32 v156, -1
    v_mov_b32 v157, -1
    v_mov_b32 v158, -1
    v_mov_b32 v159, -1
    v_mov_b32 v154, 0
    s_mul_i32 s86, s81, 14336
    s_add_u32 s86, s86, 196608
    v_cmp_gt_u32 vcc, 112, v0
    v_mov_b32 v155, 0x7fffff00
    s_mov_b32 s26, 13500416
    s_mov_b32 s27, 0x20000
    s_mov_b32 s14, 1605632
    s_mov_b32 s15, 0x20000
    s_mov_b32 s18, 1605632
    s_mov_b32 s19, 0x20000
    s_mov_b32 s22, 401408
    s_mov_b32 s23, 0x20000
    s_mov_b32 s10, 401408
    s_mov_b32 s11, 0x20000
    v_cndmask_b32 v151, v155, v148, vcc
    s_waitcnt lgkmcnt(0)
    s_load_dwordx2 s[44:45], s[0:1], 96
    s_load_dwordx2 s[46:47], s[0:1], 112
    s_mov_b32 s34, 57344
    s_mov_b32 s35, 0x20000
    s_mov_b32 s32, s24
    s_mov_b32 s33, s25
    buffer_store_dwordx4 v[156:159], v152, s[32:35], 0 offen sc1
    v_mov_b32 v172, 0
    v_mov_b32 v173, 0
    v_mov_b32 v174, 0
    v_mov_b32 v175, 0
    v_lshlrev_b32 v151, 4, v0
    v_min_u32 v154, 2032, v151
    s_add_u32 s85, s86, 0
    buffer_store_dwordx4 v[172:175], v151, s[24:27], s85 offen sc1
    s_add_u32 s85, s86, 4096
    buffer_store_dwordx4 v[172:175], v151, s[24:27], s85 offen sc1
    s_add_u32 s85, s86, 8192
    buffer_store_dwordx4 v[172:175], v151, s[24:27], s85 offen sc1
    s_add_u32 s85, s86, 12288
    buffer_store_dwordx4 v[172:175], v154, s[24:27], s85 offen sc1
    s_lshl_b32 s80, s81, 9
    s_add_u32 s80, s80, 163840
    v_min_u32 v167, 496, v151
    buffer_store_dwordx4 v[156:159], v167, s[24:27], s80 offen sc1
    s_branch L_helper2
.p2align 11
L_cont:
    s_mul_i32 s55, s48, 1792
    s_mul_i32 s56, s49, 1792
    s_mul_i32 s57, s50, 1792
    s_mul_i32 s58, s51, 1792
    s_mul_i32 s59, s52, 1792
    s_mul_i32 s60, s53, 1792
    s_mul_i32 s61, s54, 1792
    s_mov_b32 s14, 1605632
    s_mov_b32 s15, 0x20000
    s_mov_b32 s18, 1605632
    s_mov_b32 s19, 0x20000
    s_mov_b32 s22, 401408
    s_mov_b32 s23, 0x20000
    s_mov_b32 s26, 13500416
    s_mov_b32 s27, 0x20000
    s_mov_b32 s30, 3670016
    s_mov_b32 s31, 0x20000
    s_mov_b32 s34, 4096
    s_mov_b32 s35, 0x20000
    s_lshl_b32 s72, s65, 12
    s_waitcnt lgkmcnt(0)
    s_add_u32 s32, s24, s72
    s_addc_u32 s33, s25, 0
    s_load_dwordx2 s[28:29], s[0:1], 104
    v_mov_b32 v168, 0
    v_mov_b32 v169, 0
    v_mov_b32 v170, 0
    v_mov_b32 v171, 0
    s_lshl_b32 s72, s67, 10
    s_add_u32 s72, s72, 155648
    v_lshl_add_u32 v172, v206, 4, s72
    ds_write_b128 v172, v[168:171]
    v_mov_b32 v253, 0
    v_bfe_u32 v173, v206, 1, 3
    v_xor_b32 v173, v173, v153
    v_lshlrev_b32 v173, 4, v173
    v_and_b32 v174, 15, v206
    v_lshl_add_u32 v110, v174, 7, v173
    v_xor_b32 v111, 64, v110
    s_lshl_b32 s72, s67, 12
    s_lshl_b32 s73, s68, 11
    v_add_u32 v106, s72, v110
    v_add_u32 v110, s73, v110
    v_add_u32 v107, s72, v111
    v_add_u32 v111, s73, v111
    buffer_load_dwordx4 v100, s[4:7], s49 offen offset:0 lds
    v_and_b32 v173, 1, v153
    v_lshlrev_b32 v173, 2, v173
    v_xor_b32 v173, v173, v151
    v_lshlrev_b32 v173, 4, v173
    s_lshl_b32 s72, s3, 4
    v_add_u32 v174, s72, v152
    v_mul_u32_u24 v174, 3584, v174
    s_lshl_b32 s72, s65, 8
    v_add3_u32 v209, v174, v173, s72
    v_add_u32 v210, 27648, v209
    v_xor_b32 v210, 32, v210
    v_and_b32 v175, 32, v206
    v_xor_b32 v173, v173, v175
    v_add_u32 v211, 128, v209
    v_add_u32 v212, 128, v210
    s_lshl_b32 s72, s67, 5
    v_add_u32 v174, s72, v152
    v_mul_u32_u24 v174, 896, v174
    s_lshl_b32 s72, s63, 7
    v_add3_u32 v213, v174, v173, s72
    v_add_u32 v214, 6144, v213
    v_add_u32 v215, 12288, v213
    v_add_u32 v216, 18432, v213
    v_sub_u32 v173, 0, v153
    v_xor_b32 v173, v173, v206
    v_and_b32 v173, 3, v173
    v_lshlrev_b32 v173, 4, v173
    s_lshl_b32 s72, s63, 6
    v_lshrrev_b32 v174, 2, v206
    v_add_u32 v174, s72, v174
    v_mul_u32_u24 v174, 896, v174
    v_add_u32 v217, v174, v173
    v_add_u32 v218, 13312, v217
    s_lshl1_add_u32 s72, s63, s68
    s_lshl_b32 s72, s72, 5
    v_add_u32 v174, s72, v152
    v_mul_u32_u24 v174, 896, v174
    v_add_u32 v219, v174, v154
    v_add_u32 v220, v174, v155
    v_add_u32 v221, 12288, v219
    v_add_u32 v222, 18432, v220
    v_add_u32 v220, 6144, v220
    buffer_load_dwordx4 v101, s[4:7], s49 offen offset:1024 lds
    v_lshrrev_b32 v164, 3, v0
    v_bfe_u32 v165, v164, 3, 1
    v_and_b32 v166, 7, v164
    v_lshl_add_u32 v165, v165, 4, v166
    v_lshrrev_b32 v166, 4, v164
    v_lshl_add_u32 v165, v166, 3, v165
    v_bfe_u32 v166, v165, 1, 3
    v_lshrrev_b32 v167, 1, v151
    v_xor_b32 v166, v166, v167
    v_lshlrev_b32 v166, 1, v166
    v_and_or_b32 v166, v151, 1, v166
    v_lshlrev_b32 v166, 3, v166
    v_lshl_add_u32 v165, v165, 7, v166
    s_mul_i32 s74, s69, 24576
    v_add_u32 v116, s74, v165
    v_xor_b32 v117, 64, v116
    v_bfe_u32 v171, v206, 2, 2
    v_and_b32 v172, 3, v206
    v_and_b32 v173, 1, v153
    v_lshrrev_b32 v164, 1, v171
    v_lshlrev_b32 v164, 6, v164
    v_lshl_add_u32 v164, v173, 5, v164
    v_lshl_add_u32 v164, v172, 3, v164
    v_lshl_add_u32 v164, v171, 7, v164
    v_lshl_add_u32 v225, v153, 10, v164
    s_lshl_b32 s72, s68, 6
    s_add_u32 s72, s72, 16384
    v_xor_b32 v225, s72, v225
    v_xor_b32 v226, 32, v225
    v_lshl_add_u32 v227, v153, 9, v164
    s_mul_i32 s72, s68, 4128
    s_add_u32 s72, s72, 131072
    v_xor_b32 v227, s72, v227
    v_xor_b32 v228, 32, v227
    v_sub_u32 v164, 0, v171
    v_xor_b32 v164, v164, v173
    v_and_b32 v164, 3, v164
    v_lshlrev_b32 v164, 4, v164
    v_lshl_add_u32 v164, v208, 12, v164
    v_and_b32 v165, 15, v206
    v_lshl_add_u32 v229, v165, 6, v164
    s_mul_i32 s72, s68, 1056
    s_add_u32 s72, s72, 131072
    v_xor_b32 v229, s72, v229
    v_xor_b32 v230, 1024, v229
    s_add_u32 s74, s71, 155648
    v_bfe_u32 v164, v206, 2, 1
    v_xor_b32 v164, v164, v208
    v_and_b32 v165, 31, v206
    v_lshl_add_u32 v164, v165, 1, v164
    v_lshl_add_u32 v234, v164, 4, s74
    v_lshl_add_u32 v164, v208, 2, v173
    v_and_b32 v165, 15, v206
    v_lshl_add_u32 v164, v164, 5, v165
    v_lshl_add_u32 v236, v164, 3, s74
    v_xor_b32 v237, 16, v236
    s_xor_b32 s72, s64, 1
    v_xor_b32 v174, s72, v173
    s_lshl_b32 s72, s67, 7
    s_add_u32 s72, s72, 160768
    v_lshl_add_u32 v233, v208, 6, s72
    v_lshl_add_u32 v233, v174, 9, v233
    s_lshl_b32 s72, s64, 9
    s_add_u32 s72, s72, 160512
    v_lshrrev_b32 v164, 3, v0
    v_lshl_add_u32 v232, v164, 2, s72
    s_lshl_b32 s75, s62, 10
    s_add_u32 s75, s75, 3328
    s_lshl_b32 s76, s3, 8
    v_lshlrev_b32 v200, 2, v0
    v_add_u32 v200, 160512, v200
    v_lshlrev_b32 v248, 4, v206
    v_add_u32 v249, 4096, v248
    v_add_u32 v250, 8192, v248
    s_lshl_b32 s74, s67, 1
    v_add_u32 v170, s74, v208
    v_lshl_add_u32 v170, v174, 2, v170
    v_cmp_eq_u32 vcc, 7, v170
    v_lshlrev_b32 v167, 3, v207
    v_lshl_add_u32 v231, v170, 8, v167
    v_add_u32 v231, 155648, v231
    v_lshl_add_u32 v254, v208, 11, v167
    v_add_u32 v254, 155648, v254
    s_sub_u32 s74, 15, s62
    s_lshl_b32 s74, s74, 8
    s_lshl_b32 s77, s3, 10
    s_add_u32 s78, s74, s77
    s_add_u32 s78, s78, 256
    v_add_u32 v167, s74, v167
    v_lshl_add_u32 v251, v208, 11, v167
    v_mov_b32 v252, 0x10000
    v_cndmask_b32 v252, v252, v167, vcc
    v_lshlrev_b32 v170, 4, v170
    v_cvt_f32_u32 v170, v170
    buffer_load_dwordx4 v102, s[4:7], s49 offen offset:2048 lds
    buffer_load_dwordx4 v103, s[4:7], s49 offen offset:3072 lds
    s_add_u32 m0, s71, 65536
    global_load_ushort v160, v157, s[36:37]
    global_load_ushort v161, v157, s[38:39]
    global_load_ushort v162, v157, s[40:41]
    global_load_dwordx2 v[202:203], v159, s[42:43]
    global_load_dwordx2 v[204:205], v159, s[42:43] offset:64
    buffer_load_dwordx4 v104, s[8:11], s50 offen offset:0 lds
    buffer_load_dwordx4 v105, s[8:11], s50 offen offset:1024 lds
    s_add_u32 m0, s70, 49152
    s_mov_b64 exec, 0
    s_cmp_eq_u32 s3, 1
    s_cbranch_scc1 L_wm1
    s_cmp_eq_u32 s3, 2
    s_cbranch_scc1 L_wm2
    s_cmp_eq_u32 s3, 3
    s_cbranch_scc1 L_wm3
    s_branch L_wm0
L_wback:
    s_mov_b64 exec, -1
    s_waitcnt vmcnt(11) lgkmcnt(0)
    s_barrier
    ds_read_b128 a[0:3], v106 offset:0
    ds_read_b128 a[144:147], v106 offset:8192
    ds_read_b128 a[112:115], v110 offset:16384
    buffer_load_dwordx4 v100, s[4:7], s50 offen offset:0 lds
    buffer_load_dwordx4 v101, s[4:7], s50 offen offset:1024 lds
    ds_read_b128 a[4:7], v106 offset:2048
    ds_read_b128 a[148:151], v106 offset:10240
    ds_read_b128 a[116:119], v110 offset:20480
    buffer_load_dwordx4 v102, s[4:7], s50 offen offset:2048 lds
    ds_read_b128 a[8:11], v107 offset:0
    ds_read_b128 a[152:155], v107 offset:8192
    ds_read_b128 a[120:123], v111 offset:16384
    buffer_load_dwordx4 v103, s[4:7], s50 offen offset:3072 lds
    s_add_u32 m0, s71, 90112
    s_nop 0
    buffer_load_dwordx4 v104, s[8:11], s51 offen offset:0 lds
    s_waitcnt lgkmcnt(3)
    v_mfma_f32_16x16x32_bf16 v[4:7], a[0:3], a[112:115], 0
    ds_read_b128 a[12:15], v107 offset:2048
    ds_read_b128 a[156:159], v107 offset:10240
    ds_read_b128 a[124:127], v111 offset:20480
    v_mfma_f32_16x16x32_bf16 v[8:11], a[144:147], a[112:115], 0
    buffer_load_dwordx4 v105, s[8:11], s51 offen offset:1024 lds
    s_add_u32 m0, s70, 73728
    s_lshl1_add_u32 s36, s62, s64
    v_mfma_f32_16x16x32_bf16 v[24:27], a[144:147], a[116:119], 0
    s_lshl1_add_u32 s37, s67, s68
    s_lshl_b32 s37, s37, 11
    s_lshl1_add_u32 s72, s65, s68
    s_mul_i32 s44, s72, 57344
    v_mfma_f32_16x16x32_bf16 v[20:23], a[0:3], a[116:119], 0
    s_mul_i32 s72, s68, 28672
    s_lshl_b32 s74, s65, 6
    s_add_u32 s45, s72, s74
    s_waitcnt vmcnt(13)
    s_barrier
    v_mfma_f32_16x16x32_bf16 v[12:15], a[4:7], a[112:115], 0
    ds_read_b128 a[16:19], v106 offset:24576
    ds_read_b128 a[160:163], v106 offset:32768
    ds_read_b128 a[128:131], v110 offset:40960
    v_mfma_f32_16x16x32_bf16 v[16:19], a[148:151], a[112:115], 0
    buffer_load_dwordx4 v100, s[4:7], s51 offen offset:0 lds
    v_mfma_f32_16x16x32_bf16 v[32:35], a[148:151], a[116:119], 0
    buffer_load_dwordx4 v101, s[4:7], s51 offen offset:1024 lds
    s_mul_i32 s73, s36, 344064
    s_add_u32 s73, s73, 655360
    v_mfma_f32_16x16x32_bf16 v[28:31], a[4:7], a[116:119], 0
    s_mul_i32 s72, s63, 49152
    s_and_b32 s74, s3, 2
    s_xor_b32 s66, s66, s74
    s_waitcnt lgkmcnt(3)
    v_mfma_f32_16x16x32_bf16 v[4:7], a[8:11], a[120:123], v[4:7]
    ds_read_b128 a[20:23], v106 offset:26624
    ds_read_b128 a[164:167], v106 offset:34816
    ds_read_b128 a[132:135], v110 offset:45056
    v_mfma_f32_16x16x32_bf16 v[8:11], a[152:155], a[120:123], v[8:11]
    buffer_load_dwordx4 v102, s[4:7], s51 offen offset:2048 lds
    s_mul_i32 s74, s66, 12288
    v_mfma_f32_16x16x32_bf16 v[24:27], a[152:155], a[124:127], v[24:27]
    s_add_u32 s72, s72, s74
    s_add_u32 s88, s73, s72
    s_lshl_b32 s72, s68, 11
    s_add_u32 s89, s88, s72
    v_mfma_f32_16x16x32_bf16 v[20:23], a[8:11], a[124:127], v[20:23]
    s_sub_u32 s90, s89, s74
    s_xor_b32 s72, s66, 2
    s_mul_i32 s72, s72, 12288
    v_mfma_f32_16x16x32_bf16 v[12:15], a[12:15], a[120:123], v[12:15]
    ds_read_b128 a[24:27], v107 offset:24576
    ds_read_b128 a[168:171], v107 offset:32768
    ds_read_b128 a[112:115], v111 offset:40960
    v_mfma_f32_16x16x32_bf16 v[16:19], a[156:159], a[120:123], v[16:19]
    buffer_load_dwordx4 v103, s[4:7], s51 offen offset:3072 lds
    s_add_u32 m0, s71, 114688
    v_mfma_f32_16x16x32_bf16 v[32:35], a[156:159], a[124:127], v[32:35]
    buffer_load_dwordx4 v104, s[8:11], s52 offen offset:0 lds
    s_add_u32 s90, s90, s72
    s_lshl1_add_u32 s72, s64, s67
    v_mfma_f32_16x16x32_bf16 v[28:31], a[12:15], a[124:127], v[28:31]
    s_mul_i32 s87, s72, 12288
    s_add_u32 s87, s87, s73
    s_xor_b32 s72, s72, 2
    s_waitcnt lgkmcnt(3)
    v_mfma_f32_16x16x32_bf16 v[4:7], a[16:19], a[128:131], v[4:7]
    ds_read_b128 a[28:31], v107 offset:26624
    ds_read_b128 a[172:175], v107 offset:34816
    ds_read_b128 a[116:119], v111 offset:45056
    v_mfma_f32_16x16x32_bf16 v[8:11], a[160:163], a[128:131], v[8:11]
    buffer_load_dwordx4 v105, s[8:11], s52 offen offset:1024 lds
    s_add_u32 m0, s70, 98304
    s_mul_i32 s84, s72, 12288
    v_mfma_f32_16x16x32_bf16 v[24:27], a[160:163], a[132:135], v[24:27]
    s_add_u32 s84, s84, s73
    s_lshl_b32 s96, s37, 1
    s_sub_u32 s91, 0, s64
    s_xor_b32 s72, s63, s91
    v_mfma_f32_16x16x32_bf16 v[20:23], a[16:19], a[132:135], v[20:23]
    s_mul_i32 s73, s64, 7
    s_add_u32 s72, s72, s73
    s_lshl_b32 s72, s72, 2
    s_waitcnt vmcnt(8)
    s_barrier
    v_mfma_f32_16x16x32_bf16 v[12:15], a[20:23], a[128:131], v[12:15]
    ds_read_b128 a[32:35], v106 offset:49152
    ds_read_b128 a[176:179], v106 offset:57344
    v_add_u32 v110, 0x10000, v110
    ds_read_b128 a[120:123], v110 offset:0
    v_mfma_f32_16x16x32_bf16 v[16:19], a[164:167], a[128:131], v[16:19]
    buffer_load_dwordx4 v100, s[4:7], s52 offen offset:0 lds
    v_mfma_f32_16x16x32_bf16 v[32:35], a[164:167], a[132:135], v[32:35]
    buffer_load_dwordx4 v101, s[4:7], s52 offen offset:1024 lds
    s_lshr_b32 s92, 0x4422, s72
    s_and_b32 s92, s92, 7
    v_mfma_f32_16x16x32_bf16 v[28:31], a[20:23], a[132:135], v[28:31]
    s_lshr_b32 s93, 0x2220044, s72
    s_and_b32 s93, s93, 7
    s_lshr_b32 s94, 0x4452301, s72
    s_waitcnt lgkmcnt(3)
    v_mfma_f32_16x16x32_bf16 v[4:7], a[24:27], a[112:115], v[4:7]
    ds_read_b128 a[36:39], v106 offset:51200
    ds_read_b128 a[180:183], v106 offset:59392
    ds_read_b128 a[124:127], v110 offset:4096
L_wm0:
L_is0:
    s_cbranch_execz L_wback
    v_mfma_f32_16x16x32_bf16 v[8:11], a[168:171], a[112:115], v[8:11]
    buffer_load_dwordx4 v102, s[4:7], s52 offen offset:2048 lds
    s_and_b32 s94, s94, 7
    v_mfma_f32_16x16x32_bf16 v[24:27], a[168:171], a[116:119], v[24:27]
    s_lshr_b32 s95, 0x5666666, s72
    s_and_b32 s95, s95, 7
    s_sub_u32 s95, s95, s94
    s_lshl_b32 s72, s95, 6
    v_mfma_f32_16x16x32_bf16 v[20:23], a[24:27], a[116:119], v[20:23]
    s_sub_u32 s72, s72, 64
    v_bfe_u32 v164, v154, 6, 1
    v_mul_u32_u24 v223, s72, v164
    v_mfma_f32_16x16x32_bf16 v[12:15], a[28:31], a[112:115], v[12:15]
    ds_read_b128 a[40:43], v107 offset:49152
    ds_read_b128 a[184:187], v107 offset:57344
    v_add_u32 v111, 0x10000, v111
    ds_read_b128 a[128:131], v111 offset:0
    v_mfma_f32_16x16x32_bf16 v[16:19], a[172:175], a[112:115], v[16:19]
    buffer_load_dwordx4 v103, s[4:7], s52 offen offset:3072 lds
    s_add_u32 m0, s71, 139264
    v_mfma_f32_16x16x32_bf16 v[32:35], a[172:175], a[116:119], v[32:35]
    buffer_load_dwordx4 v104, s[8:11], s53 offen offset:0 lds
    v_sub_u32 v224, s72, v223
    v_mfma_f32_16x16x32_bf16 v[28:31], a[28:31], a[116:119], v[28:31]
    s_xor_b32 s62, s68, s64
    s_add_u32 s72, s92, s62
    s_add_u32 s74, s92, s64
    s_xor_b32 s74, s74, s91
    s_waitcnt lgkmcnt(3)
    v_mfma_f32_16x16x32_bf16 v[4:7], a[32:35], a[120:123], v[4:7]
    ds_read_b128 a[44:47], v107 offset:51200
    ds_read_b128 a[188:191], v107 offset:59392
    ds_read_b128 a[132:135], v111 offset:4096
    v_mfma_f32_16x16x32_bf16 v[8:11], a[176:179], a[120:123], v[8:11]
    buffer_load_dwordx4 v105, s[8:11], s53 offen offset:1024 lds
    s_add_u32 m0, s70, 122880
    s_lshl1_add_u32 s74, s73, s74
    v_mfma_f32_16x16x32_bf16 v[24:27], a[176:179], a[124:127], v[24:27]
    s_lshl_b32 s79, s74, 6
    s_xor_b32 s72, s72, s91
    s_add_u32 s72, s72, s73
    v_mov_b32 v255, s72
    s_mul_i32 s74, s72, 49152
    v_mfma_f32_16x16x32_bf16 v[20:23], a[32:35], a[124:127], v[20:23]
    s_add_u32 s82, s84, s74
    s_add_u32 s85, s87, s74
    s_add_u32 s72, s72, s73
    s_waitcnt vmcnt(8)
    s_barrier
    ds_read_b64 v[240:241], v116 offset:8192
    ds_read_b64 v[242:243], v116 offset:12288
    ds_read_b64 v[244:245], v117 offset:8192
    ds_read_b64 v[246:247], v117 offset:12288
    v_mfma_f32_16x16x32_bf16 v[12:15], a[36:39], a[120:123], v[12:15]
    v_add_u32 v106, 0x12000, v106
    ds_read_b128 a[48:51], v106 offset:0
    ds_read_b128 a[192:195], v106 offset:8192
    ds_read_b128 a[112:115], v110 offset:24576
    v_mfma_f32_16x16x32_bf16 v[16:19], a[180:183], a[120:123], v[16:19]
    buffer_load_dwordx4 v100, s[4:7], s53 offen offset:0 lds
    v_mfma_f32_16x16x32_bf16 v[32:35], a[180:183], a[124:127], v[32:35]
    buffer_load_dwordx4 v101, s[4:7], s53 offen offset:1024 lds
    s_mul_i32 s38, s72, 114688
    s_add_u32 s41, s38, 57344
    v_mfma_f32_16x16x32_bf16 v[28:31], a[36:39], a[124:127], v[28:31]
    s_add_u32 s72, s93, s62
    s_add_u32 s74, s93, s64
    s_xor_b32 s74, s74, s91
    s_waitcnt lgkmcnt(7)
    v_mfma_f32_16x16x32_bf16 v[4:7], a[40:43], a[128:131], v[4:7]
    ds_read_b128 a[52:55], v106 offset:2048
    ds_read_b128 a[196:199], v106 offset:10240
    ds_read_b128 a[116:119], v110 offset:28672
    v_mfma_f32_16x16x32_bf16 v[8:11], a[184:187], a[128:131], v[8:11]
    buffer_load_dwordx4 v102, s[4:7], s53 offen offset:2048 lds
    s_lshl1_add_u32 s74, s73, s74
    s_lshl_b32 s80, s74, 6
    v_mfma_f32_16x16x32_bf16 v[24:27], a[184:187], a[132:135], v[24:27]
    s_xor_b32 s72, s72, s91
    s_add_u32 s72, s72, s73
    v_cmp_eq_u32 vcc, 1, v172
    v_mov_b32 v164, s72
    v_mfma_f32_16x16x32_bf16 v[20:23], a[40:43], a[132:135], v[20:23]
    s_mul_i32 s74, s72, 49152
    s_add_u32 s83, s84, s74
    s_add_u32 s86, s87, s74
    v_mfma_f32_16x16x32_bf16 v[12:15], a[44:47], a[128:131], v[12:15]
    v_add_u32 v107, 0x12000, v107
    ds_read_b128 a[56:59], v107 offset:0
    ds_read_b128 a[200:203], v107 offset:8192
    ds_read_b128 a[120:123], v111 offset:24576
    v_mfma_f32_16x16x32_bf16 v[16:19], a[188:191], a[128:131], v[16:19]
    buffer_load_dwordx4 v103, s[4:7], s53 offen offset:3072 lds
    s_add_u32 m0, s71, 147456
    v_mfma_f32_16x16x32_bf16 v[32:35], a[188:191], a[132:135], v[32:35]
    buffer_load_dwordx4 v104, s[8:11], s54 offen offset:0 lds
    v_cndmask_b32 v255, v255, v164, vcc
    v_mfma_f32_16x16x32_bf16 v[28:31], a[44:47], a[132:135], v[28:31]
    s_add_u32 s72, s72, s73
    s_mul_i32 s39, s72, 114688
    s_add_u32 s42, s39, 57344
    s_mul_i32 s72, s95, s62
    s_waitcnt lgkmcnt(3)
    v_mfma_f32_16x16x32_bf16 v[4:7], a[48:51], a[112:115], v[4:7]
    ds_read_b128 a[60:63], v107 offset:2048
    ds_read_b128 a[204:207], v107 offset:10240
    ds_read_b128 a[124:127], v111 offset:28672
    v_mfma_f32_16x16x32_bf16 v[8:11], a[192:195], a[112:115], v[8:11]
    buffer_load_dwordx4 v105, s[8:11], s54 offen offset:1024 lds
    s_add_u32 m0, s70, 0
    s_add_u32 s72, s72, s94
    v_mfma_f32_16x16x32_bf16 v[24:27], a[192:195], a[116:119], v[24:27]
    s_mul_i32 s74, s95, s64
    s_add_u32 s74, s74, s94
    s_xor_b32 s74, s74, s91
    s_lshl1_add_u32 s74, s73, s74
    s_lshl_b32 s81, s74, 6
    v_mfma_f32_16x16x32_bf16 v[20:23], a[48:51], a[116:119], v[20:23]
    s_xor_b32 s72, s72, s91
    s_add_u32 s72, s72, s73
    v_cmp_eq_u32 vcc, 2, v172
    s_waitcnt vmcnt(8)
    s_barrier
    v_mfma_f32_16x16x32_bf16 v[12:15], a[52:55], a[112:115], v[12:15]
    ds_read_b128 a[64:67], v106 offset:24576
    ds_read_b128 a[208:211], v106 offset:32768
    ds_read_b128 a[128:131], v110 offset:49152
    v_mfma_f32_16x16x32_bf16 v[16:19], a[196:199], a[112:115], v[16:19]
    buffer_load_dwordx4 v100, s[4:7], s54 offen offset:0 lds
    v_mfma_f32_16x16x32_bf16 v[32:35], a[196:199], a[116:119], v[32:35]
    buffer_load_dwordx4 v101, s[4:7], s54 offen offset:1024 lds
    v_mov_b32 v164, s72
    s_mul_i32 s74, s72, 49152
    v_mfma_f32_16x16x32_bf16 v[28:31], a[52:55], a[116:119], v[28:31]
    s_add_u32 s84, s84, s74
    s_add_u32 s87, s87, s74
    v_cndmask_b32 v255, v255, v164, vcc
    s_waitcnt lgkmcnt(3)
    v_mfma_f32_16x16x32_bf16 v[4:7], a[56:59], a[120:123], v[4:7]
    ds_read_b128 a[68:71], v106 offset:26624
    ds_read_b128 a[212:215], v106 offset:34816
    ds_read_b128 a[132:135], v110 offset:53248
    v_mfma_f32_16x16x32_bf16 v[8:11], a[200:203], a[120:123], v[8:11]
    buffer_load_dwordx4 v102, s[4:7], s54 offen offset:2048 lds
    s_add_u32 s72, s72, s73
    s_mul_i32 s40, s72, 114688
    v_mfma_f32_16x16x32_bf16 v[24:27], a[200:203], a[124:127], v[24:27]
    s_add_u32 s43, s40, 57344
    v_lshl_add_u32 v255, v255, 1, v208
    v_lshlrev_b32 v255, 10, v255
    s_mul_i32 s72, s36, 28
    v_mfma_f32_16x16x32_bf16 v[20:23], a[56:59], a[124:127], v[20:23]
    s_add_u32 s72, s72, s67
    s_lshl_b32 s72, s72, 9
    s_add_u32 s64, s72, 196608
    v_mfma_f32_16x16x32_bf16 v[12:15], a[60:63], a[120:123], v[12:15]
    ds_read_b128 a[72:75], v107 offset:24576
    ds_read_b128 a[216:219], v107 offset:32768
    ds_read_b128 a[112:115], v111 offset:49152
    v_mfma_f32_16x16x32_bf16 v[16:19], a[204:207], a[120:123], v[16:19]
    buffer_load_dwordx4 v103, s[4:7], s54 offen offset:3072 lds
    s_add_u32 m0, s71, 16384
    v_mfma_f32_16x16x32_bf16 v[32:35], a[204:207], a[124:127], v[32:35]
    buffer_load_dwordx4 v209, s[12:15], s55 offen offset:0 lds
    s_mul_i32 s65, s36, 7
    s_add_u32 s65, s65, s63
    v_mfma_f32_16x16x32_bf16 v[28:31], a[60:63], a[124:127], v[28:31]
    s_lshl2_add_u32 s72, s65, s3
    s_lshl_b32 s72, s72, 9
    s_add_u32 s62, s72, 196608
    s_waitcnt lgkmcnt(3)
    v_mfma_f32_16x16x32_bf16 v[4:7], a[64:67], a[128:131], v[4:7]
    ds_read_b128 a[76:79], v107 offset:26624
    ds_read_b128 a[220:223], v107 offset:34816
    ds_read_b128 a[116:119], v111 offset:53248
    v_mfma_f32_16x16x32_bf16 v[8:11], a[208:211], a[128:131], v[8:11]
    buffer_load_dwordx4 v210, s[12:15], s55 offen offset:1024 lds
    s_add_u32 m0, s71, 24576
    s_xor_b32 s72, s36, 1
    v_mfma_f32_16x16x32_bf16 v[24:27], a[208:211], a[132:135], v[24:27]
    s_mul_i32 s69, s72, 7
    s_add_u32 s69, s69, s63
    s_mov_b32 s66, 1
    s_mov_b32 s67, 1
    s_mov_b32 s91, 1
    v_mfma_f32_16x16x32_bf16 v[20:23], a[64:67], a[132:135], v[20:23]
    s_mov_b32 s74, 0x3fb8aa3b
    v_lshlrev_b32 v160, 16, v160
    v_lshlrev_b32 v161, 16, v161
    s_waitcnt vmcnt(8)
    s_barrier
    v_mfma_f32_16x16x32_bf16 v[12:15], a[68:71], a[128:131], v[12:15]
    ds_read_b128 a[80:83], v106 offset:49152
    ds_read_b128 a[224:227], v106 offset:57344
    v_add_u32 v110, 0x12000, v110
    ds_read_b128 a[120:123], v110 offset:0
    v_mfma_f32_16x16x32_bf16 v[16:19], a[212:215], a[128:131], v[16:19]
    buffer_load_dwordx4 v209, s[12:15], s56 offen offset:0 lds
    buffer_load_dwordx4 v210, s[12:15], s56 offen offset:1024 lds
    v_mfma_f32_16x16x32_bf16 v[32:35], a[212:215], a[132:135], v[32:35]
    s_add_u32 m0, s71, 32768
    v_lshlrev_b32 v162, 16, v162
    v_mul_f32 v164, s74, v162
    v_mfma_f32_16x16x32_bf16 v[28:31], a[68:71], a[132:135], v[28:31]
    v_fma_f32 v165, v162, s74, -v164
    v_fmac_f32 v165, 0x32a57060, v162
    v_exp_f32 v164, v164
    s_waitcnt lgkmcnt(3)
    v_mfma_f32_16x16x32_bf16 v[4:7], a[72:75], a[112:115], v[4:7]
    ds_read_b128 a[84:87], v106 offset:51200
    ds_read_b128 a[228:231], v106 offset:59392
    ds_read_b128 a[124:127], v110 offset:4096
    v_mfma_f32_16x16x32_bf16 v[8:11], a[216:219], a[112:115], v[8:11]
    buffer_load_dwordx4 v209, s[12:15], s57 offen offset:0 lds
    v_mul_f32 v165, 0x3f317218, v165
    v_fmac_f32 v164, v164, v165
    v_mfma_f32_16x16x32_bf16 v[24:27], a[216:219], a[116:119], v[24:27]
    v_cvt_pk_bf16_f32 v164, v164, v164
    v_lshlrev_b32 v164, 16, v164
    v_mul_f32 v168, v164, v160
    v_mul_f32 v169, v164, v161
    v_mfma_f32_16x16x32_bf16 v[20:23], a[72:75], a[116:119], v[20:23]
    v_mul_f32 v168, s74, v168
    v_mul_f32 v169, 0.15915494, v169
    v_exp_f32 v164, v168
    v_mfma_f32_16x16x32_bf16 v[12:15], a[76:79], a[112:115], v[12:15]
    ds_read_b128 a[88:91], v107 offset:49152
    ds_read_b128 a[232:235], v107 offset:57344
    v_add_u32 v111, 0x12000, v111
    ds_read_b128 a[128:131], v111 offset:0
    v_mfma_f32_16x16x32_bf16 v[16:19], a[220:223], a[112:115], v[16:19]
    buffer_load_dwordx4 v210, s[12:15], s57 offen offset:1024 lds
    s_add_u32 m0, s71, 40960
    v_mfma_f32_16x16x32_bf16 v[32:35], a[220:223], a[116:119], v[32:35]
    buffer_load_dwordx4 v209, s[12:15], s58 offen offset:0 lds
    v_rndne_f32 v166, v169
    v_sub_f32 v165, v169, v166
    v_mfma_f32_16x16x32_bf16 v[28:31], a[76:79], a[116:119], v[28:31]
    v_cos_f32 v180, v165
    v_sin_f32 v181, v165
    v_mul_f32 v180, v164, v180
    s_waitcnt lgkmcnt(3)
    v_mfma_f32_16x16x32_bf16 v[4:7], a[80:83], a[120:123], v[4:7]
    ds_read_b128 a[92:95], v107 offset:51200
    ds_read_b128 a[236:239], v107 offset:59392
    ds_read_b128 a[132:135], v111 offset:4096
    buffer_load_dwordx4 v210, s[12:15], s58 offen offset:1024 lds
    v_mfma_f32_16x16x32_bf16 v[8:11], a[224:227], a[120:123], v[8:11]
    s_add_u32 m0, s71, 49152
    v_mul_f32 v181, v164, v181
    v_mul_f32 v164, 0x41000000, v168
    v_mfma_f32_16x16x32_bf16 v[24:27], a[224:227], a[124:127], v[24:27]
    v_mul_f32 v165, 0x41000000, v169
    v_exp_f32 v164, v164
    v_rndne_f32 v166, v165
    v_sub_f32 v165, v165, v166
    v_mfma_f32_16x16x32_bf16 v[20:23], a[80:83], a[124:127], v[20:23]
    v_cos_f32 v182, v165
    v_sin_f32 v183, v165
    v_mul_f32 v182, v164, v182
    s_waitcnt vmcnt(8)
    s_barrier
    global_load_dword v1, v253, s[46:47] sc1
    v_mfma_f32_16x16x32_bf16 v[12:15], a[84:87], a[120:123], v[12:15]
    v_add_u32 v106, 0xfffee000, v106
    ds_read_b128 a[96:99], v106 offset:0
    ds_read_b128 a[240:243], v106 offset:8192
    ds_read_b128 a[112:115], v110 offset:8192
    v_mfma_f32_16x16x32_bf16 v[16:19], a[228:231], a[120:123], v[16:19]
    buffer_load_dwordx4 v209, s[12:15], s59 offen offset:0 lds
    buffer_load_dwordx4 v210, s[12:15], s59 offen offset:1024 lds
    v_mfma_f32_16x16x32_bf16 v[32:35], a[228:231], a[124:127], v[32:35]
    s_add_u32 m0, s71, 57344
    v_mul_f32 v183, v164, v183
    v_mul_f32 v164, 0x41800000, v168
    v_mfma_f32_16x16x32_bf16 v[28:31], a[84:87], a[124:127], v[28:31]
    v_mul_f32 v165, 0x41800000, v169
    v_exp_f32 v164, v164
    v_rndne_f32 v166, v165
    s_waitcnt lgkmcnt(3)
    v_mfma_f32_16x16x32_bf16 v[4:7], a[88:91], a[128:131], v[4:7]
    ds_read_b128 a[100:103], v106 offset:2048
    ds_read_b128 a[244:247], v106 offset:10240
    ds_read_b128 a[116:119], v110 offset:12288
    v_mfma_f32_16x16x32_bf16 v[8:11], a[232:235], a[128:131], v[8:11]
    buffer_load_dwordx4 v209, s[12:15], s60 offen offset:0 lds
    v_sub_f32 v165, v165, v166
    v_cos_f32 v184, v165
    v_mfma_f32_16x16x32_bf16 v[24:27], a[232:235], a[132:135], v[24:27]
    v_sin_f32 v185, v165
    v_mul_f32 v184, v164, v184
    v_mul_f32 v185, v164, v185
    v_mul_f32 v164, 0x43000000, v168
    v_mfma_f32_16x16x32_bf16 v[20:23], a[88:91], a[132:135], v[20:23]
    v_mul_f32 v165, 0x43000000, v169
    v_exp_f32 v164, v164
    v_rndne_f32 v166, v165
    v_mfma_f32_16x16x32_bf16 v[12:15], a[92:95], a[128:131], v[12:15]
    v_add_u32 v107, 0xfffee000, v107
    ds_read_b128 a[104:107], v107 offset:0
    ds_read_b128 a[248:251], v107 offset:8192
    ds_read_b128 a[120:123], v111 offset:8192
    v_mfma_f32_16x16x32_bf16 v[16:19], a[236:239], a[128:131], v[16:19]
    buffer_load_dwordx4 v210, s[12:15], s60 offen offset:1024 lds
    s_add_u32 m0, s71, 65536
    v_mfma_f32_16x16x32_bf16 v[32:35], a[236:239], a[132:135], v[32:35]
    buffer_load_dwordx4 v209, s[12:15], s61 offen offset:0 lds
    v_sub_f32 v165, v165, v166
    v_cos_f32 v186, v165
    v_mfma_f32_16x16x32_bf16 v[28:31], a[92:95], a[132:135], v[28:31]
    v_sin_f32 v187, v165
    v_mul_f32 v186, v164, v186
    v_mul_f32 v187, v164, v187
    s_waitcnt lgkmcnt(3)
    v_mfma_f32_16x16x32_bf16 v[4:7], a[96:99], a[112:115], v[4:7]
    ds_read_b128 a[108:111], v107 offset:2048
    ds_read_b128 a[252:255], v107 offset:10240
    ds_read_b128 a[124:127], v111 offset:12288
    buffer_load_dwordx4 v210, s[12:15], s61 offen offset:1024 lds
    v_mfma_f32_16x16x32_bf16 v[8:11], a[240:243], a[112:115], v[8:11]
    s_add_u32 m0, s71, 73728
    v_mul_f32 v164, 0x44800000, v168
    v_mul_f32 v165, 0x44800000, v169
    v_mfma_f32_16x16x32_bf16 v[24:27], a[240:243], a[116:119], v[24:27]
    v_exp_f32 v164, v164
    v_rndne_f32 v166, v165
    v_sub_f32 v165, v165, v166
    v_cos_f32 v188, v165
    v_mfma_f32_16x16x32_bf16 v[20:23], a[96:99], a[116:119], v[20:23]
    v_sin_f32 v189, v165
    v_mul_f32 v188, v164, v188
    v_mul_f32 v189, v164, v189
    v_mfma_f32_16x16x32_bf16 v[12:15], a[100:103], a[112:115], v[12:15]
    buffer_load_dwordx4 v211, s[12:15], s55 offen offset:0 lds
    v_mfma_f32_16x16x32_bf16 v[16:19], a[244:247], a[112:115], v[16:19]
    buffer_load_dwordx4 v212, s[12:15], s55 offen offset:1024 lds
    v_mfma_f32_16x16x32_bf16 v[32:35], a[244:247], a[116:119], v[32:35]
    s_add_u32 m0, s71, 81920
    v_mul_f32 v164, v170, v168
    v_mul_f32 v165, v170, v169
    v_exp_f32 v164, v164
    v_mfma_f32_16x16x32_bf16 v[28:31], a[100:103], a[116:119], v[28:31]
    v_rndne_f32 v166, v165
    v_sub_f32 v165, v165, v166
    s_waitcnt lgkmcnt(0)
    v_mfma_f32_16x16x32_bf16 v[4:7], a[104:107], a[120:123], v[4:7]
    buffer_load_dwordx4 v211, s[12:15], s56 offen offset:0 lds
    v_mfma_f32_16x16x32_bf16 v[8:11], a[248:251], a[120:123], v[8:11]
    v_cos_f32 v190, v165
    v_sin_f32 v191, v165
    v_mul_f32 v190, v164, v190
    v_mfma_f32_16x16x32_bf16 v[24:27], a[248:251], a[124:127], v[24:27]
    v_mul_f32 v191, v164, v191
    v_mul_f32 v164, v160, v160
    v_fmac_f32 v164, v161, v161
    v_mfma_f32_16x16x32_bf16 v[20:23], a[104:107], a[124:127], v[20:23]
    v_rcp_f32 v164, v164
    v_add_f32 v165, -1.0, v180
    v_add_f32 v164, v164, v164
    v_mfma_f32_16x16x32_bf16 v[12:15], a[108:111], a[120:123], v[12:15]
    buffer_load_dwordx4 v212, s[12:15], s56 offen offset:1024 lds
    s_add_u32 m0, s71, 90112
    s_nop 0
    buffer_load_dwordx4 v211, s[12:15], s57 offen offset:0 lds
    v_mul_f32 v192, v165, v160
    v_mfma_f32_16x16x32_bf16 v[16:19], a[252:255], a[120:123], v[16:19]
    v_fmac_f32 v192, v181, v161
    v_mul_f32 v193, v181, v160
    v_fma_f32 v193, -v165, v161, v193
    v_mul_f32 v192, v164, v192
    buffer_load_dwordx4 v212, s[12:15], s57 offen offset:1024 lds
    s_add_u32 m0, s71, 98304
    v_mfma_f32_16x16x32_bf16 v[32:35], a[252:255], a[124:127], v[32:35]
    v_mul_f32 v193, v164, v193
    buffer_load_dwordx4 v211, s[12:15], s58 offen offset:0 lds
    v_permlane16_swap_b32 v4, v8
    buffer_load_dwordx4 v212, s[12:15], s58 offen offset:1024 lds
    v_mfma_f32_16x16x32_bf16 v[28:31], a[108:111], a[124:127], v[28:31]
    s_add_u32 m0, s71, 106496
    v_permlane16_swap_b32 v5, v9
    v_permlane16_swap_b32 v6, v10
    v_permlane16_swap_b32 v7, v11
    v_permlane16_swap_b32 v20, v24
    v_permlane16_swap_b32 v21, v25
    v_permlane16_swap_b32 v22, v26
    v_permlane16_swap_b32 v23, v27
    v_permlane16_swap_b32 v12, v16
    v_permlane16_swap_b32 v13, v17
    v_permlane16_swap_b32 v14, v18
    v_permlane16_swap_b32 v15, v19
    v_permlane16_swap_b32 v28, v32
    v_permlane16_swap_b32 v29, v33
    v_permlane16_swap_b32 v30, v34
    v_permlane16_swap_b32 v31, v35
    v_pk_fma_f32 v[152:153], v[180:181], v[4:5], v[6:7] op_sel_hi:[0,1,1]
    v_pk_fma_f32 v[154:155], v[180:181], v[20:21], v[22:23] op_sel_hi:[0,1,1]
    v_pk_fma_f32 v[152:153], v[180:181], v[20:21], v[152:153] op_sel:[1,0,0] neg_lo:[1,0,0] neg_hi:[1,0,0]
    buffer_load_dwordx4 v211, s[12:15], s59 offen offset:0 lds
    v_pk_fma_f32 v[154:155], v[180:181], v[4:5], v[154:155] op_sel:[1,0,0]
    v_pk_fma_f32 v[148:149], v[180:181], v[152:153], v[8:9] op_sel_hi:[0,1,1]
    v_pk_fma_f32 v[150:151], v[180:181], v[154:155], v[24:25] op_sel_hi:[0,1,1]
    v_pk_fma_f32 v[148:149], v[180:181], v[154:155], v[148:149] op_sel:[1,0,0] neg_lo:[1,0,0] neg_hi:[1,0,0]
    v_pk_fma_f32 v[150:151], v[180:181], v[152:153], v[150:151] op_sel:[1,0,0]
    v_pk_fma_f32 v[152:153], v[180:181], v[148:149], v[10:11] op_sel_hi:[0,1,1]
    v_pk_fma_f32 v[154:155], v[180:181], v[150:151], v[26:27] op_sel_hi:[0,1,1]
    v_pk_fma_f32 v[152:153], v[180:181], v[150:151], v[152:153] op_sel:[1,0,0] neg_lo:[1,0,0] neg_hi:[1,0,0]
    v_pk_fma_f32 v[154:155], v[180:181], v[148:149], v[154:155] op_sel:[1,0,0]
    v_pk_fma_f32 v[148:149], v[180:181], v[152:153], v[12:13] op_sel_hi:[0,1,1]
    v_pk_fma_f32 v[150:151], v[180:181], v[154:155], v[28:29] op_sel_hi:[0,1,1]
    v_pk_fma_f32 v[148:149], v[180:181], v[154:155], v[148:149] op_sel:[1,0,0] neg_lo:[1,0,0] neg_hi:[1,0,0]
    v_pk_fma_f32 v[150:151], v[180:181], v[152:153], v[150:151] op_sel:[1,0,0]
    v_pk_fma_f32 v[152:153], v[180:181], v[148:149], v[14:15] op_sel_hi:[0,1,1]
    v_pk_fma_f32 v[154:155], v[180:181], v[150:151], v[30:31] op_sel_hi:[0,1,1]
    v_pk_fma_f32 v[152:153], v[180:181], v[150:151], v[152:153] op_sel:[1,0,0] neg_lo:[1,0,0] neg_hi:[1,0,0]
    v_pk_fma_f32 v[154:155], v[180:181], v[148:149], v[154:155] op_sel:[1,0,0]
    v_pk_fma_f32 v[148:149], v[180:181], v[152:153], v[16:17] op_sel_hi:[0,1,1]
    v_pk_fma_f32 v[150:151], v[180:181], v[154:155], v[32:33] op_sel_hi:[0,1,1]
    buffer_load_dwordx4 v212, s[12:15], s59 offen offset:1024 lds
    s_add_u32 m0, s71, 114688
    v_pk_fma_f32 v[148:149], v[180:181], v[154:155], v[148:149] op_sel:[1,0,0] neg_lo:[1,0,0] neg_hi:[1,0,0]
    v_pk_fma_f32 v[150:151], v[180:181], v[152:153], v[150:151] op_sel:[1,0,0]
    v_pk_fma_f32 v[152:153], v[180:181], v[148:149], v[18:19] op_sel_hi:[0,1,1]
    v_pk_fma_f32 v[154:155], v[180:181], v[150:151], v[34:35] op_sel_hi:[0,1,1]
    v_pk_fma_f32 v[152:153], v[180:181], v[150:151], v[152:153] op_sel:[1,0,0] neg_lo:[1,0,0] neg_hi:[1,0,0]
    v_pk_fma_f32 v[154:155], v[180:181], v[148:149], v[154:155] op_sel:[1,0,0]
    v_mov_b32 v198, v152
    v_mov_b32 v199, v154
    v_mov_b32 v154, v153
    v_pk_fma_f32 v[196:197], v[182:183], v[198:199], v[154:155] op_sel_hi:[0,1,1]
    v_pk_fma_f32 v[196:197], v[182:183], v[198:199], v[196:197] op_sel:[1,1,0] op_sel_hi:[1,0,1] neg_lo:[1,0,0]
    ds_write_b64 v231, v[196:197] offset:1792
    v_pk_mul_f32 v[164:165], v[192:193], v[20:21] op_sel:[1,0]
    v_pk_mul_f32 v[166:167], v[192:193], v[4:5] op_sel:[1,0]
    v_pk_fma_f32 v[4:5], v[192:193], v[4:5], v[164:165] op_sel_hi:[0,1,1] neg_lo:[0,0,1] neg_hi:[0,0,1]
    v_pk_fma_f32 v[20:21], v[192:193], v[20:21], v[166:167] op_sel_hi:[0,1,1] neg_lo:[1,0,1] neg_hi:[1,0,1]
    v_pk_mul_f32 v[164:165], v[192:193], v[22:23] op_sel:[1,0]
    v_pk_mul_f32 v[166:167], v[192:193], v[6:7] op_sel:[1,0]
    buffer_load_dwordx4 v211, s[12:15], s60 offen offset:0 lds
    v_pk_fma_f32 v[6:7], v[192:193], v[6:7], v[164:165] op_sel_hi:[0,1,1] neg_lo:[0,0,1] neg_hi:[0,0,1]
    v_pk_fma_f32 v[22:23], v[192:193], v[22:23], v[166:167] op_sel_hi:[0,1,1] neg_lo:[1,0,1] neg_hi:[1,0,1]
    v_pk_mul_f32 v[164:165], v[192:193], v[24:25] op_sel:[1,0]
    v_pk_mul_f32 v[166:167], v[192:193], v[8:9] op_sel:[1,0]
    v_pk_fma_f32 v[8:9], v[192:193], v[8:9], v[164:165] op_sel_hi:[0,1,1] neg_lo:[0,0,1] neg_hi:[0,0,1]
    v_pk_fma_f32 v[24:25], v[192:193], v[24:25], v[166:167] op_sel_hi:[0,1,1] neg_lo:[1,0,1] neg_hi:[1,0,1]
    v_pk_mul_f32 v[164:165], v[192:193], v[26:27] op_sel:[1,0]
    v_pk_mul_f32 v[166:167], v[192:193], v[10:11] op_sel:[1,0]
    v_pk_fma_f32 v[10:11], v[192:193], v[10:11], v[164:165] op_sel_hi:[0,1,1] neg_lo:[0,0,1] neg_hi:[0,0,1]
    v_pk_fma_f32 v[26:27], v[192:193], v[26:27], v[166:167] op_sel_hi:[0,1,1] neg_lo:[1,0,1] neg_hi:[1,0,1]
    s_waitcnt vmcnt(9) lgkmcnt(0)
    s_barrier
    ds_read_b64 v[162:163], v231 offset:0
    ds_read_b64 v[160:161], v231 offset:256
    ds_read_b64 v[158:159], v231 offset:512
    ds_read_b64 v[156:157], v231 offset:768
    ds_read_b64 v[154:155], v231 offset:1024
    ds_read_b64 v[152:153], v231 offset:1280
    buffer_load_dwordx4 v212, s[12:15], s60 offen offset:1024 lds
    s_add_u32 m0, s71, 122880
    ds_read_b64 v[150:151], v231 offset:1536
    ds_read_b64_tr_b16 a[112:113], v225 offset:0
    ds_read_b64_tr_b16 a[114:115], v225 offset:512
    ds_read_b64_tr_b16 a[116:117], v226 offset:0
    ds_read_b64_tr_b16 a[118:119], v226 offset:512
    ds_read_b64_tr_b16 a[120:121], v225 offset:4096
    ds_read_b64_tr_b16 a[122:123], v225 offset:4608
    v_pk_mul_f32 v[164:165], v[192:193], v[28:29] op_sel:[1,0]
    v_pk_mul_f32 v[166:167], v[192:193], v[12:13] op_sel:[1,0]
    v_pk_fma_f32 v[12:13], v[192:193], v[12:13], v[164:165] op_sel_hi:[0,1,1] neg_lo:[0,0,1] neg_hi:[0,0,1]
    v_pk_fma_f32 v[28:29], v[192:193], v[28:29], v[166:167] op_sel_hi:[0,1,1] neg_lo:[1,0,1] neg_hi:[1,0,1]
    v_pk_mul_f32 v[164:165], v[192:193], v[30:31] op_sel:[1,0]
    v_pk_mul_f32 v[166:167], v[192:193], v[14:15] op_sel:[1,0]
    v_pk_fma_f32 v[14:15], v[192:193], v[14:15], v[164:165] op_sel_hi:[0,1,1] neg_lo:[0,0,1] neg_hi:[0,0,1]
    v_pk_fma_f32 v[30:31], v[192:193], v[30:31], v[166:167] op_sel_hi:[0,1,1] neg_lo:[1,0,1] neg_hi:[1,0,1]
    v_pk_mul_f32 v[164:165], v[192:193], v[32:33] op_sel:[1,0]
    v_pk_mul_f32 v[166:167], v[192:193], v[16:17] op_sel:[1,0]
    v_pk_fma_f32 v[16:17], v[192:193], v[16:17], v[164:165] op_sel_hi:[0,1,1] neg_lo:[0,0,1] neg_hi:[0,0,1]
    buffer_load_dwordx4 v211, s[12:15], s61 offen offset:0 lds
    v_pk_fma_f32 v[32:33], v[192:193], v[32:33], v[166:167] op_sel_hi:[0,1,1] neg_lo:[1,0,1] neg_hi:[1,0,1]
    v_pk_mul_f32 v[164:165], v[192:193], v[34:35] op_sel:[1,0]
    v_pk_mul_f32 v[166:167], v[192:193], v[18:19] op_sel:[1,0]
    v_pk_fma_f32 v[18:19], v[192:193], v[18:19], v[164:165] op_sel_hi:[0,1,1] neg_lo:[0,0,1] neg_hi:[0,0,1]
    v_pk_fma_f32 v[34:35], v[192:193], v[34:35], v[166:167] op_sel_hi:[0,1,1] neg_lo:[1,0,1] neg_hi:[1,0,1]
    v_cmp_gt_u32 vcc, 32, v1
    s_cbranch_vccnz L_retry_ready
L_ok_ready:
    s_waitcnt lgkmcnt(6)
    v_pk_fma_f32 v[194:195], v[184:185], v[162:163], v[160:161] op_sel_hi:[0,1,1]
    v_pk_fma_f32 v[194:195], v[184:185], v[162:163], v[194:195] op_sel:[1,1,0] op_sel_hi:[1,0,1] neg_lo:[1,0,0]
    v_pk_fma_f32 v[2:3], v[184:185], v[194:195], v[158:159] op_sel_hi:[0,1,1]
    v_pk_fma_f32 v[2:3], v[184:185], v[194:195], v[2:3] op_sel:[1,1,0] op_sel_hi:[1,0,1] neg_lo:[1,0,0]
    v_pk_fma_f32 v[194:195], v[184:185], v[2:3], v[156:157] op_sel_hi:[0,1,1]
    v_pk_fma_f32 v[194:195], v[184:185], v[2:3], v[194:195] op_sel:[1,1,0] op_sel_hi:[1,0,1] neg_lo:[1,0,0]
    v_pk_fma_f32 v[2:3], v[184:185], v[194:195], v[154:155] op_sel_hi:[0,1,1]
    v_pk_fma_f32 v[2:3], v[184:185], v[194:195], v[2:3] op_sel:[1,1,0] op_sel_hi:[1,0,1] neg_lo:[1,0,0]
    v_pk_fma_f32 v[194:195], v[184:185], v[2:3], v[152:153] op_sel_hi:[0,1,1]
    v_pk_fma_f32 v[194:195], v[184:185], v[2:3], v[194:195] op_sel:[1,1,0] op_sel_hi:[1,0,1] neg_lo:[1,0,0]
    v_pk_fma_f32 v[2:3], v[184:185], v[194:195], v[150:151] op_sel_hi:[0,1,1]
    v_pk_fma_f32 v[2:3], v[184:185], v[194:195], v[2:3] op_sel:[1,1,0] op_sel_hi:[1,0,1] neg_lo:[1,0,0]
    v_pk_fma_f32 v[194:195], v[184:185], v[2:3], v[196:197] op_sel_hi:[0,1,1]
    buffer_load_dwordx4 v212, s[12:15], s61 offen offset:1024 lds
    s_add_u32 m0, s70, 139264
    v_pk_fma_f32 v[194:195], v[184:185], v[2:3], v[194:195] op_sel:[1,1,0] op_sel_hi:[1,0,1] neg_lo:[1,0,0]
    v_min_u32 v194, -2, v194
    v_min_u32 v195, -2, v195
    buffer_store_dwordx2 v[194:195], v252, s[32:35], 0 offen sc1
    s_waitcnt lgkmcnt(2)
    v_mfma_f32_16x16x32_bf16 v[36:39], a[112:115], a[0:3], 0
    ds_read_b64_tr_b16 a[124:125], v226 offset:4096
    ds_read_b64_tr_b16 a[126:127], v226 offset:4608
    v_mfma_f32_16x16x32_bf16 v[40:43], a[116:119], a[0:3], 0
    buffer_load_dwordx4 v213, s[16:19], s44 offen offset:0 lds
    v_mfma_f32_16x16x32_bf16 v[44:47], a[112:115], a[4:7], 0
    v_mfma_f32_16x16x32_bf16 v[48:51], a[116:119], a[4:7], 0
    v_mfma_f32_16x16x32_bf16 v[52:55], a[112:115], a[144:147], 0
    ds_read_b64_tr_b16 a[128:129], v225 offset:8192
    ds_read_b64_tr_b16 a[130:131], v225 offset:8704
    v_mfma_f32_16x16x32_bf16 v[56:59], a[116:119], a[144:147], 0
    buffer_load_dwordx4 v214, s[16:19], s44 offen offset:1024 lds
    v_mfma_f32_16x16x32_bf16 v[60:63], a[112:115], a[148:151], 0
    v_mfma_f32_16x16x32_bf16 v[64:67], a[116:119], a[148:151], 0
    s_waitcnt lgkmcnt(2)
    v_mfma_f32_16x16x32_bf16 v[36:39], a[120:123], a[8:11], v[36:39]
    ds_read_b64_tr_b16 a[132:133], v226 offset:8192
    ds_read_b64_tr_b16 a[134:135], v226 offset:8704
    v_mfma_f32_16x16x32_bf16 v[40:43], a[124:127], a[8:11], v[40:43]
    buffer_load_dwordx4 v215, s[16:19], s44 offen offset:2048 lds
    v_mfma_f32_16x16x32_bf16 v[44:47], a[120:123], a[12:15], v[44:47]
    v_mfma_f32_16x16x32_bf16 v[48:51], a[124:127], a[12:15], v[48:51]
    v_mfma_f32_16x16x32_bf16 v[52:55], a[120:123], a[152:155], v[52:55]
    ds_read_b64_tr_b16 a[136:137], v225 offset:12288
    ds_read_b64_tr_b16 a[138:139], v225 offset:12800
    v_mfma_f32_16x16x32_bf16 v[56:59], a[124:127], a[152:155], v[56:59]
    buffer_load_dwordx4 v216, s[16:19], s44 offen offset:3072 lds
    v_mfma_f32_16x16x32_bf16 v[60:63], a[120:123], a[156:159], v[60:63]
    v_mfma_f32_16x16x32_bf16 v[64:67], a[124:127], a[156:159], v[64:67]
    s_add_u32 m0, s37, 131072
    s_waitcnt lgkmcnt(2)
    v_mfma_f32_16x16x32_bf16 v[36:39], a[128:131], a[16:19], v[36:39]
    ds_read_b64_tr_b16 a[140:141], v226 offset:12288
    ds_read_b64_tr_b16 a[142:143], v226 offset:12800
    v_mfma_f32_16x16x32_bf16 v[40:43], a[132:135], a[16:19], v[40:43]
    buffer_load_dwordx4 v217, s[20:23], s45 offen offset:0 lds
    v_mfma_f32_16x16x32_bf16 v[44:47], a[128:131], a[20:23], v[44:47]
    v_mfma_f32_16x16x32_bf16 v[48:51], a[132:135], a[20:23], v[48:51]
    v_mfma_f32_16x16x32_bf16 v[52:55], a[128:131], a[160:163], v[52:55]
    ds_read_b64_tr_b16 a[112:113], v225 offset:16384
    ds_read_b64_tr_b16 a[114:115], v225 offset:16896
    v_mfma_f32_16x16x32_bf16 v[56:59], a[132:135], a[160:163], v[56:59]
    buffer_load_dwordx4 v218, s[20:23], s45 offen offset:1024 lds
    v_mfma_f32_16x16x32_bf16 v[60:63], a[128:131], a[164:167], v[60:63]
    v_mfma_f32_16x16x32_bf16 v[64:67], a[132:135], a[164:167], v[64:67]
    s_add_u32 m0, s70, 0
    s_waitcnt lgkmcnt(2)
    v_mfma_f32_16x16x32_bf16 v[36:39], a[136:139], a[24:27], v[36:39]
    ds_read_b64_tr_b16 a[116:117], v226 offset:16384
    ds_read_b64_tr_b16 a[118:119], v226 offset:16896
    v_mfma_f32_16x16x32_bf16 v[40:43], a[140:143], a[24:27], v[40:43]
    buffer_load_dwordx4 v213, s[16:19], s38 offen offset:0 lds
    v_mfma_f32_16x16x32_bf16 v[44:47], a[136:139], a[28:31], v[44:47]
    v_mfma_f32_16x16x32_bf16 v[48:51], a[140:143], a[28:31], v[48:51]
    v_mfma_f32_16x16x32_bf16 v[52:55], a[136:139], a[168:171], v[52:55]
    ds_read_b64_tr_b16 a[120:121], v225 offset:20480
    ds_read_b64_tr_b16 a[122:123], v225 offset:20992
    v_mfma_f32_16x16x32_bf16 v[56:59], a[140:143], a[168:171], v[56:59]
    buffer_load_dwordx4 v214, s[16:19], s38 offen offset:1024 lds
    v_mfma_f32_16x16x32_bf16 v[60:63], a[136:139], a[172:175], v[60:63]
    v_mfma_f32_16x16x32_bf16 v[64:67], a[140:143], a[172:175], v[64:67]
    s_waitcnt lgkmcnt(2)
    v_mfma_f32_16x16x32_bf16 v[36:39], a[112:115], a[32:35], v[36:39]
    ds_read_b64_tr_b16 a[124:125], v226 offset:20480
    ds_read_b64_tr_b16 a[126:127], v226 offset:20992
    v_mfma_f32_16x16x32_bf16 v[40:43], a[116:119], a[32:35], v[40:43]
    buffer_load_dwordx4 v215, s[16:19], s38 offen offset:2048 lds
    v_mfma_f32_16x16x32_bf16 v[44:47], a[112:115], a[36:39], v[44:47]
    v_mfma_f32_16x16x32_bf16 v[48:51], a[116:119], a[36:39], v[48:51]
    v_mfma_f32_16x16x32_bf16 v[52:55], a[112:115], a[176:179], v[52:55]
    ds_read_b64_tr_b16 a[128:129], v225 offset:24576
    ds_read_b64_tr_b16 a[130:131], v225 offset:25088
    v_mfma_f32_16x16x32_bf16 v[56:59], a[116:119], a[176:179], v[56:59]
    buffer_load_dwordx4 v216, s[16:19], s38 offen offset:3072 lds
    v_mfma_f32_16x16x32_bf16 v[60:63], a[112:115], a[180:183], v[60:63]
    v_mfma_f32_16x16x32_bf16 v[64:67], a[116:119], a[180:183], v[64:67]
    s_add_u32 m0, s70, 16384
    s_waitcnt lgkmcnt(2)
    v_mfma_f32_16x16x32_bf16 v[36:39], a[120:123], a[40:43], v[36:39]
    ds_read_b64_tr_b16 a[132:133], v226 offset:24576
    ds_read_b64_tr_b16 a[134:135], v226 offset:25088
    v_mfma_f32_16x16x32_bf16 v[40:43], a[124:127], a[40:43], v[40:43]
    v_mfma_f32_16x16x32_bf16 v[44:47], a[120:123], a[44:47], v[44:47]
    v_mfma_f32_16x16x32_bf16 v[48:51], a[124:127], a[44:47], v[48:51]
    s_waitcnt vmcnt(11)
    s_barrier
    buffer_load_dwordx4 v213, s[16:19], s39 offen offset:0 lds
    v_mfma_f32_16x16x32_bf16 v[52:55], a[120:123], a[184:187], v[52:55]
    ds_read_b64_tr_b16 a[136:137], v225 offset:28672
    ds_read_b64_tr_b16 a[138:139], v225 offset:29184
    v_mfma_f32_16x16x32_bf16 v[56:59], a[124:127], a[184:187], v[56:59]
    buffer_load_dwordx4 v214, s[16:19], s39 offen offset:1024 lds
    v_mfma_f32_16x16x32_bf16 v[60:63], a[120:123], a[188:191], v[60:63]
    v_mfma_f32_16x16x32_bf16 v[64:67], a[124:127], a[188:191], v[64:67]
    s_waitcnt lgkmcnt(2)
    v_mfma_f32_16x16x32_bf16 v[36:39], a[128:131], a[48:51], v[36:39]
    ds_read_b64_tr_b16 a[140:141], v226 offset:28672
    ds_read_b64_tr_b16 a[142:143], v226 offset:29184
L_wm1:
L_is1:
    s_cbranch_execz L_wback
    v_mfma_f32_16x16x32_bf16 v[40:43], a[132:135], a[48:51], v[40:43]
    buffer_load_dwordx4 v215, s[16:19], s39 offen offset:2048 lds
    v_mfma_f32_16x16x32_bf16 v[44:47], a[128:131], a[52:55], v[44:47]
    v_mfma_f32_16x16x32_bf16 v[48:51], a[132:135], a[52:55], v[48:51]
    v_mfma_f32_16x16x32_bf16 v[52:55], a[128:131], a[192:195], v[52:55]
    ds_read_b64_tr_b16 a[112:113], v225 offset:32768
    ds_read_b64_tr_b16 a[114:115], v225 offset:33280
    v_mfma_f32_16x16x32_bf16 v[56:59], a[132:135], a[192:195], v[56:59]
    buffer_load_dwordx4 v216, s[16:19], s39 offen offset:3072 lds
    v_mfma_f32_16x16x32_bf16 v[60:63], a[128:131], a[196:199], v[60:63]
    v_mfma_f32_16x16x32_bf16 v[64:67], a[132:135], a[196:199], v[64:67]
    s_add_u32 m0, s70, 32768
    s_waitcnt lgkmcnt(2)
    v_mfma_f32_16x16x32_bf16 v[36:39], a[136:139], a[56:59], v[36:39]
    ds_read_b64_tr_b16 a[116:117], v226 offset:32768
    ds_read_b64_tr_b16 a[118:119], v226 offset:33280
    v_mfma_f32_16x16x32_bf16 v[40:43], a[140:143], a[56:59], v[40:43]
    v_mfma_f32_16x16x32_bf16 v[44:47], a[136:139], a[60:63], v[44:47]
    v_mfma_f32_16x16x32_bf16 v[48:51], a[140:143], a[60:63], v[48:51]
    v_mfma_f32_16x16x32_bf16 v[52:55], a[136:139], a[200:203], v[52:55]
    ds_read_b64_tr_b16 a[120:121], v225 offset:36864
    ds_read_b64_tr_b16 a[122:123], v225 offset:37376
    v_mfma_f32_16x16x32_bf16 v[56:59], a[140:143], a[200:203], v[56:59]
    v_mfma_f32_16x16x32_bf16 v[60:63], a[136:139], a[204:207], v[60:63]
    v_mfma_f32_16x16x32_bf16 v[64:67], a[140:143], a[204:207], v[64:67]
    s_waitcnt lgkmcnt(2)
    v_mfma_f32_16x16x32_bf16 v[36:39], a[112:115], a[64:67], v[36:39]
    ds_read_b64_tr_b16 a[124:125], v226 offset:36864
    ds_read_b64_tr_b16 a[126:127], v226 offset:37376
    v_mfma_f32_16x16x32_bf16 v[40:43], a[116:119], a[64:67], v[40:43]
    v_mfma_f32_16x16x32_bf16 v[44:47], a[112:115], a[68:71], v[44:47]
    v_mfma_f32_16x16x32_bf16 v[48:51], a[116:119], a[68:71], v[48:51]
    s_waitcnt vmcnt(10)
    s_barrier
    buffer_load_dwordx4 v213, s[16:19], s40 offen offset:0 lds
    v_mfma_f32_16x16x32_bf16 v[52:55], a[112:115], a[208:211], v[52:55]
    ds_read_b64_tr_b16 a[128:129], v225 offset:40960
    ds_read_b64_tr_b16 a[130:131], v225 offset:41472
    v_mfma_f32_16x16x32_bf16 v[56:59], a[116:119], a[208:211], v[56:59]
    buffer_load_dwordx4 v214, s[16:19], s40 offen offset:1024 lds
    v_mfma_f32_16x16x32_bf16 v[60:63], a[112:115], a[212:215], v[60:63]
    v_mfma_f32_16x16x32_bf16 v[64:67], a[116:119], a[212:215], v[64:67]
    s_waitcnt lgkmcnt(2)
    v_mfma_f32_16x16x32_bf16 v[36:39], a[120:123], a[72:75], v[36:39]
    ds_read_b64_tr_b16 a[132:133], v226 offset:40960
    ds_read_b64_tr_b16 a[134:135], v226 offset:41472
    v_mfma_f32_16x16x32_bf16 v[40:43], a[124:127], a[72:75], v[40:43]
    buffer_load_dwordx4 v215, s[16:19], s40 offen offset:2048 lds
    v_mfma_f32_16x16x32_bf16 v[44:47], a[120:123], a[76:79], v[44:47]
    v_mfma_f32_16x16x32_bf16 v[48:51], a[124:127], a[76:79], v[48:51]
    v_mfma_f32_16x16x32_bf16 v[52:55], a[120:123], a[216:219], v[52:55]
    ds_read_b64_tr_b16 a[136:137], v225 offset:45056
    ds_read_b64_tr_b16 a[138:139], v225 offset:45568
    v_mfma_f32_16x16x32_bf16 v[56:59], a[124:127], a[216:219], v[56:59]
    buffer_load_dwordx4 v216, s[16:19], s40 offen offset:3072 lds
    v_mfma_f32_16x16x32_bf16 v[60:63], a[120:123], a[220:223], v[60:63]
    v_mfma_f32_16x16x32_bf16 v[64:67], a[124:127], a[220:223], v[64:67]
    s_add_u32 m0, s96, 49152
    s_waitcnt lgkmcnt(2)
    v_mfma_f32_16x16x32_bf16 v[36:39], a[128:131], a[80:83], v[36:39]
    ds_read_b64_tr_b16 a[140:141], v226 offset:45056
    ds_read_b64_tr_b16 a[142:143], v226 offset:45568
    v_mfma_f32_16x16x32_bf16 v[40:43], a[132:135], a[80:83], v[40:43]
    v_mfma_f32_16x16x32_bf16 v[44:47], a[128:131], a[84:87], v[44:47]
    v_mfma_f32_16x16x32_bf16 v[48:51], a[132:135], a[84:87], v[48:51]
    v_mfma_f32_16x16x32_bf16 v[52:55], a[128:131], a[224:227], v[52:55]
    ds_read_b64_tr_b16 a[112:113], v225 offset:49152
    ds_read_b64_tr_b16 a[114:115], v225 offset:49664
    v_mfma_f32_16x16x32_bf16 v[56:59], a[132:135], a[224:227], v[56:59]
    v_mfma_f32_16x16x32_bf16 v[60:63], a[128:131], a[228:231], v[60:63]
    v_mfma_f32_16x16x32_bf16 v[64:67], a[132:135], a[228:231], v[64:67]
    s_waitcnt lgkmcnt(2)
    v_mfma_f32_16x16x32_bf16 v[36:39], a[136:139], a[88:91], v[36:39]
    ds_read_b64_tr_b16 a[116:117], v226 offset:49152
    ds_read_b64_tr_b16 a[118:119], v226 offset:49664
    s_add_u32 m0, s77, 155648
    v_mfma_f32_16x16x32_bf16 v[40:43], a[140:143], a[88:91], v[40:43]
    buffer_load_dwordx4 v248, s[32:35], s78 offen sc1 lds
    v_mfma_f32_16x16x32_bf16 v[44:47], a[136:139], a[92:95], v[44:47]
    s_add_u32 m0, s76, 160512
    s_nop 0
    buffer_load_dword v200, s[24:27], s75 offen sc1 lds
    v_mfma_f32_16x16x32_bf16 v[48:51], a[140:143], a[92:95], v[48:51]
    s_add_u32 m0, s96, 49152
    v_mfma_f32_16x16x32_bf16 v[52:55], a[136:139], a[232:235], v[52:55]
    ds_read_b64_tr_b16 a[120:121], v225 offset:53248
    ds_read_b64_tr_b16 a[122:123], v225 offset:53760
    v_mfma_f32_16x16x32_bf16 v[56:59], a[140:143], a[232:235], v[56:59]
    v_mfma_f32_16x16x32_bf16 v[60:63], a[136:139], a[236:239], v[60:63]
    v_mfma_f32_16x16x32_bf16 v[64:67], a[140:143], a[236:239], v[64:67]
    s_waitcnt lgkmcnt(2)
    v_mfma_f32_16x16x32_bf16 v[36:39], a[112:115], a[96:99], v[36:39]
    ds_read_b64_tr_b16 a[124:125], v226 offset:53248
    ds_read_b64_tr_b16 a[126:127], v226 offset:53760
    v_mfma_f32_16x16x32_bf16 v[40:43], a[116:119], a[96:99], v[40:43]
    v_mfma_f32_16x16x32_bf16 v[44:47], a[112:115], a[100:103], v[44:47]
    v_mfma_f32_16x16x32_bf16 v[48:51], a[116:119], a[100:103], v[48:51]
    s_waitcnt vmcnt(10)
    s_barrier
    v_add_u32 v219, v223, v219
    buffer_load_dwordx4 v219, s[20:23], s81 offen offset:0 lds
    v_mfma_f32_16x16x32_bf16 v[52:55], a[112:115], a[240:243], v[52:55]
    ds_read_b64_tr_b16 a[128:129], v225 offset:57344
    ds_read_b64_tr_b16 a[130:131], v225 offset:57856
    v_mfma_f32_16x16x32_bf16 v[56:59], a[116:119], a[240:243], v[56:59]
    v_add_u32 v220, v224, v220
    v_mfma_f32_16x16x32_bf16 v[60:63], a[112:115], a[244:247], v[60:63]
    buffer_load_dwordx4 v220, s[20:23], s81 offen offset:1024 lds
    v_mfma_f32_16x16x32_bf16 v[64:67], a[116:119], a[244:247], v[64:67]
    s_waitcnt lgkmcnt(2)
    v_mfma_f32_16x16x32_bf16 v[36:39], a[120:123], a[104:107], v[36:39]
    ds_read_b64_tr_b16 a[132:133], v226 offset:57344
    ds_read_b64_tr_b16 a[134:135], v226 offset:57856
    v_mfma_f32_16x16x32_bf16 v[40:43], a[124:127], a[104:107], v[40:43]
    v_add_u32 v221, v223, v221
    v_mfma_f32_16x16x32_bf16 v[44:47], a[120:123], a[108:111], v[44:47]
    buffer_load_dwordx4 v221, s[20:23], s81 offen offset:2048 lds
    v_mfma_f32_16x16x32_bf16 v[48:51], a[124:127], a[108:111], v[48:51]
    v_mfma_f32_16x16x32_bf16 v[52:55], a[120:123], a[248:251], v[52:55]
    ds_read_b64_tr_b16 a[136:137], v225 offset:61440
    ds_read_b64_tr_b16 a[138:139], v225 offset:61952
    v_add_u32 v222, v224, v222
    buffer_load_dwordx4 v222, s[20:23], s81 offen offset:3072 lds
    v_mfma_f32_16x16x32_bf16 v[56:59], a[124:127], a[248:251], v[56:59]
    s_add_u32 m0, s96, 65536
    ds_read_b64_tr_b16 a[140:141], v226 offset:61440
    ds_read_b64_tr_b16 a[142:143], v226 offset:61952
    v_mfma_f32_16x16x32_bf16 v[60:63], a[120:123], a[252:255], v[60:63]
    v_add_u32 v225, 0x10000, v225
    ds_read_b64_tr_b16 a[112:113], v225 offset:0
    ds_read_b64_tr_b16 a[114:115], v225 offset:512
    v_add_u32 v226, 0x10000, v226
    ds_read_b64_tr_b16 a[116:117], v226 offset:0
    v_mfma_f32_16x16x32_bf16 v[64:67], a[124:127], a[252:255], v[64:67]
    ds_read_b64_tr_b16 a[118:119], v226 offset:512
    v_cvt_pk_bf16_f32 v100, v36, v37
    v_cvt_pk_bf16_f32 v101, v38, v39
    v_cvt_pk_bf16_f32 v102, v40, v41
    ds_read_b64_tr_b16 a[120:121], v225 offset:4096
    ds_read_b64_tr_b16 a[122:123], v225 offset:4608
    v_cvt_pk_bf16_f32 v103, v42, v43
    v_pk_max_i16 v100, v100, 0
    v_pk_max_i16 v101, v101, 0
    ds_read_b64_tr_b16 a[124:125], v226 offset:4096
    ds_read_b64_tr_b16 a[126:127], v226 offset:4608
    v_pk_max_i16 v102, v102, 0
    v_pk_max_i16 v103, v103, 0
    v_cvt_pk_bf16_f32 v104, v44, v45
    ds_read_b64_tr_b16 v[36:37], v225 offset:8192
    ds_read_b64_tr_b16 v[38:39], v225 offset:8704
    v_cvt_pk_bf16_f32 v105, v46, v47
    s_waitcnt vmcnt(4) lgkmcnt(10)
    s_barrier
    ds_read_b64 v[162:163], v254 offset:1792
    ds_read_b64 v[160:161], v254 offset:1536
    ds_read_b64 v[158:159], v254 offset:1280
    ds_read_b64 v[156:157], v254 offset:1024
    ds_read_b64 v[154:155], v254 offset:768
    ds_read_b64 v[152:153], v254 offset:512
    ds_read_b64 v[150:151], v254 offset:256
    ds_read_b64 v[148:149], v254 offset:0
    ds_read_b128 v[164:167], v233 offset:0
    ds_read_b128 v[168:171], v233 offset:16
    ds_read_b128 v[172:175], v233 offset:32
    ds_read_b128 v[176:179], v233 offset:48
    ds_read_b32 v238, v232 offset:0
    ds_read_b32 v239, v232 offset:128
    v_sub_u32 v219, v219, v223
    buffer_load_dwordx4 v219, s[20:23], s79 offen offset:0 lds
    v_cvt_pk_bf16_f32 v106, v48, v49
    v_sub_u32 v220, v220, v224
    buffer_load_dwordx4 v220, s[20:23], s79 offen offset:1024 lds
    v_cvt_pk_bf16_f32 v107, v50, v51
    v_sub_u32 v221, v221, v223
    buffer_load_dwordx4 v221, s[20:23], s79 offen offset:2048 lds
    ds_read_b64_tr_b16 v[40:41], v226 offset:8192
    ds_read_b64_tr_b16 v[42:43], v226 offset:8704
    v_sub_u32 v222, v222, v224
    buffer_load_dwordx4 v222, s[20:23], s79 offen offset:3072 lds
    s_add_u32 m0, s96, 81920
    v_pk_max_i16 v104, v104, 0
    v_pk_max_i16 v105, v105, 0
    v_pk_max_i16 v106, v106, 0
    ds_read_b64_tr_b16 v[44:45], v225 offset:12288
    ds_read_b64_tr_b16 v[46:47], v225 offset:12800
    v_pk_max_i16 v107, v107, 0
    v_cvt_pk_bf16_f32 v108, v52, v53
    v_cvt_pk_bf16_f32 v109, v54, v55
    ds_read_b64_tr_b16 v[48:49], v226 offset:12288
    ds_read_b64_tr_b16 v[50:51], v226 offset:12800
    v_cvt_pk_bf16_f32 v110, v56, v57
    v_cvt_pk_bf16_f32 v111, v58, v59
    v_pk_max_i16 v108, v108, 0
    v_pk_max_i16 v109, v109, 0
    v_pk_max_i16 v110, v110, 0
    v_pk_max_i16 v111, v111, 0
    v_cvt_pk_bf16_f32 v112, v60, v61
    v_cvt_pk_bf16_f32 v113, v62, v63
    v_cvt_pk_bf16_f32 v114, v64, v65
    v_cvt_pk_bf16_f32 v115, v66, v67
    v_pk_max_i16 v112, v112, 0
    v_pk_max_i16 v113, v113, 0
    v_pk_max_i16 v114, v114, 0
    v_pk_max_i16 v115, v115, 0
    s_waitcnt lgkmcnt(12)
    v_max3_u32 v194, v148, v149, v150
    v_max3_u32 v194, v194, v151, v152
    v_max3_u32 v194, v194, v153, v154
    v_max3_u32 v194, v194, v155, v156
    v_max3_u32 v194, v194, v157, v158
    v_max3_u32 v194, v194, v159, v160
    v_max3_u32 v194, v194, v161, v162
    s_waitcnt lgkmcnt(11)
    v_max3_u32 v194, v194, v163, v164
    v_max3_u32 v194, v194, v165, v166
    s_waitcnt lgkmcnt(10)
    v_max3_u32 v194, v194, v167, v168
    v_max3_u32 v194, v194, v169, v170
    s_waitcnt lgkmcnt(9)
    v_max3_u32 v194, v194, v171, v172
    v_max3_u32 v194, v194, v173, v174
    s_waitcnt lgkmcnt(8)
    v_max3_u32 v194, v194, v175, v176
    v_max3_u32 v194, v194, v177, v178
    s_waitcnt lgkmcnt(7)
    v_max3_u32 v194, v194, v179, v238
    s_waitcnt lgkmcnt(6)
    v_max_u32 v194, v194, v239
    v_cmp_eq_u32 vcc, -1, v194
    s_cbranch_vccnz L_retry_fin
L_ok_fin:
    buffer_store_dwordx4 v[100:103], v248, s[24:27], s89 offen offset:0 sc1
    v_pk_fma_f32 v[194:195], v[186:187], v[162:163], v[160:161] op_sel_hi:[0,1,1]
    v_pk_fma_f32 v[194:195], v[186:187], v[162:163], v[194:195] op_sel:[1,1,0] op_sel_hi:[1,0,1] neg_lo:[1,0,0]
    v_pk_fma_f32 v[196:197], v[186:187], v[194:195], v[158:159] op_sel_hi:[0,1,1]
    v_pk_fma_f32 v[196:197], v[186:187], v[194:195], v[196:197] op_sel:[1,1,0] op_sel_hi:[1,0,1] neg_lo:[1,0,0]
    v_pk_fma_f32 v[194:195], v[186:187], v[196:197], v[156:157] op_sel_hi:[0,1,1]
    v_pk_fma_f32 v[194:195], v[186:187], v[196:197], v[194:195] op_sel:[1,1,0] op_sel_hi:[1,0,1] neg_lo:[1,0,0]
    v_pk_fma_f32 v[196:197], v[186:187], v[194:195], v[154:155] op_sel_hi:[0,1,1]
    v_pk_fma_f32 v[196:197], v[186:187], v[194:195], v[196:197] op_sel:[1,1,0] op_sel_hi:[1,0,1] neg_lo:[1,0,0]
    v_pk_fma_f32 v[194:195], v[186:187], v[196:197], v[152:153] op_sel_hi:[0,1,1]
    v_pk_fma_f32 v[194:195], v[186:187], v[196:197], v[194:195] op_sel:[1,1,0] op_sel_hi:[1,0,1] neg_lo:[1,0,0]
    v_pk_fma_f32 v[196:197], v[186:187], v[194:195], v[150:151] op_sel_hi:[0,1,1]
    v_pk_fma_f32 v[196:197], v[186:187], v[194:195], v[196:197] op_sel:[1,1,0] op_sel_hi:[1,0,1] neg_lo:[1,0,0]
    v_pk_fma_f32 v[194:195], v[186:187], v[196:197], v[148:149] op_sel_hi:[0,1,1]
    buffer_store_dwordx4 v[104:107], v248, s[24:27], s89 offen offset:1024 sc1
    v_pk_fma_f32 v[194:195], v[186:187], v[196:197], v[194:195] op_sel:[1,1,0] op_sel_hi:[1,0,1] neg_lo:[1,0,0]
    v_mov_b32 v196, v194
    v_mov_b32 v197, v195
    s_nop 0
    v_permlane32_swap_b32 v194, v196
    v_permlane32_swap_b32 v195, v197
    v_pk_fma_f32 v[148:149], v[188:189], v[196:197], v[194:195] op_sel_hi:[0,1,1]
    v_pk_fma_f32 v[148:149], v[188:189], v[196:197], v[148:149] op_sel:[1,1,0] op_sel_hi:[1,0,1] neg_lo:[1,0,0]
    v_pk_fma_f32 v[150:151], v[190:191], v[148:149], v[2:3] op_sel_hi:[0,1,1]
    v_pk_fma_f32 v[150:151], v[190:191], v[148:149], v[150:151] op_sel:[1,1,0] op_sel_hi:[1,0,1] neg_lo:[1,0,0]
    v_pk_fma_f32 v[152:153], v[182:183], v[150:151], v[198:199] op_sel_hi:[0,1,1]
    v_pk_fma_f32 v[152:153], v[182:183], v[150:151], v[152:153] op_sel:[1,1,0] op_sel_hi:[1,0,1] neg_lo:[1,0,0]
    v_swap_b32 v151, v152
    v_pk_mul_f32 v[194:195], v[192:193], v[152:153] op_sel:[1,0]
    buffer_store_dwordx4 v[108:111], v248, s[24:27], s90 offen offset:0 sc1
    v_pk_mul_f32 v[196:197], v[192:193], v[150:151] op_sel:[1,0]
    v_pk_fma_f32 v[150:151], v[192:193], v[150:151], v[194:195] op_sel_hi:[0,1,1] neg_lo:[0,0,1] neg_hi:[0,0,1]
    v_pk_fma_f32 v[152:153], v[192:193], v[152:153], v[196:197] op_sel_hi:[0,1,1] neg_lo:[1,0,1] neg_hi:[1,0,1]
    v_pk_fma_f32 v[4:5], v[180:181], v[150:151], v[4:5] op_sel_hi:[0,1,1]
    v_pk_fma_f32 v[20:21], v[180:181], v[152:153], v[20:21] op_sel_hi:[0,1,1]
    v_pk_fma_f32 v[4:5], v[180:181], v[152:153], v[4:5] op_sel:[1,0,0]
    v_pk_fma_f32 v[20:21], v[180:181], v[150:151], v[20:21] op_sel:[1,0,0] neg_lo:[1,0,0] neg_hi:[1,0,0]
    v_pk_fma_f32 v[6:7], v[180:181], v[4:5], v[6:7] op_sel_hi:[0,1,1]
    v_pk_fma_f32 v[22:23], v[180:181], v[20:21], v[22:23] op_sel_hi:[0,1,1]
    v_pk_fma_f32 v[6:7], v[180:181], v[20:21], v[6:7] op_sel:[1,0,0]
    v_pk_fma_f32 v[22:23], v[180:181], v[4:5], v[22:23] op_sel:[1,0,0] neg_lo:[1,0,0] neg_hi:[1,0,0]
    v_pk_fma_f32 v[8:9], v[180:181], v[6:7], v[8:9] op_sel_hi:[0,1,1]
    v_pk_fma_f32 v[24:25], v[180:181], v[22:23], v[24:25] op_sel_hi:[0,1,1]
    buffer_store_dwordx4 v[112:115], v248, s[24:27], s90 offen offset:1024 sc1
    v_pk_fma_f32 v[8:9], v[180:181], v[22:23], v[8:9] op_sel:[1,0,0]
    v_pk_fma_f32 v[24:25], v[180:181], v[6:7], v[24:25] op_sel:[1,0,0] neg_lo:[1,0,0] neg_hi:[1,0,0]
    v_pk_fma_f32 v[10:11], v[180:181], v[8:9], v[10:11] op_sel_hi:[0,1,1]
    v_pk_fma_f32 v[26:27], v[180:181], v[24:25], v[26:27] op_sel_hi:[0,1,1]
    v_pk_fma_f32 v[10:11], v[180:181], v[24:25], v[10:11] op_sel:[1,0,0]
    v_pk_fma_f32 v[26:27], v[180:181], v[8:9], v[26:27] op_sel:[1,0,0] neg_lo:[1,0,0] neg_hi:[1,0,0]
    v_pk_fma_f32 v[12:13], v[180:181], v[10:11], v[12:13] op_sel_hi:[0,1,1]
    v_pk_fma_f32 v[28:29], v[180:181], v[26:27], v[28:29] op_sel_hi:[0,1,1]
    v_pk_fma_f32 v[12:13], v[180:181], v[26:27], v[12:13] op_sel:[1,0,0]
    v_pk_fma_f32 v[28:29], v[180:181], v[10:11], v[28:29] op_sel:[1,0,0] neg_lo:[1,0,0] neg_hi:[1,0,0]
    v_pk_fma_f32 v[14:15], v[180:181], v[12:13], v[14:15] op_sel_hi:[0,1,1]
    v_pk_fma_f32 v[30:31], v[180:181], v[28:29], v[30:31] op_sel_hi:[0,1,1]
    v_pk_fma_f32 v[14:15], v[180:181], v[28:29], v[14:15] op_sel:[1,0,0]
    v_pk_fma_f32 v[30:31], v[180:181], v[12:13], v[30:31] op_sel:[1,0,0] neg_lo:[1,0,0] neg_hi:[1,0,0]
    v_pk_fma_f32 v[16:17], v[180:181], v[14:15], v[16:17] op_sel_hi:[0,1,1]
    v_pk_fma_f32 v[32:33], v[180:181], v[30:31], v[32:33] op_sel_hi:[0,1,1]
    v_pk_fma_f32 v[16:17], v[180:181], v[30:31], v[16:17] op_sel:[1,0,0]
    v_pk_fma_f32 v[32:33], v[180:181], v[14:15], v[32:33] op_sel:[1,0,0] neg_lo:[1,0,0] neg_hi:[1,0,0]
    v_pk_fma_f32 v[18:19], v[180:181], v[16:17], v[18:19] op_sel_hi:[0,1,1]
    v_pk_fma_f32 v[34:35], v[180:181], v[32:33], v[34:35] op_sel_hi:[0,1,1]
    v_pk_fma_f32 v[18:19], v[180:181], v[32:33], v[18:19] op_sel:[1,0,0]
    v_pk_fma_f32 v[34:35], v[180:181], v[16:17], v[34:35] op_sel:[1,0,0] neg_lo:[1,0,0] neg_hi:[1,0,0]
    v_pk_mul_f32 v[4:5], v[164:165], v[4:5]
    v_pk_mul_f32 v[6:7], v[166:167], v[6:7]
    v_pk_mul_f32 v[8:9], v[168:169], v[8:9]
    v_pk_mul_f32 v[10:11], v[170:171], v[10:11]
    v_pk_mul_f32 v[12:13], v[172:173], v[12:13]
    v_pk_mul_f32 v[14:15], v[174:175], v[14:15]
    v_pk_mul_f32 v[16:17], v[176:177], v[16:17]
    v_pk_mul_f32 v[18:19], v[178:179], v[18:19]
    v_pk_mul_f32 v[20:21], v[164:165], v[20:21]
    v_pk_mul_f32 v[22:23], v[166:167], v[22:23]
    v_pk_mul_f32 v[24:25], v[168:169], v[24:25]
    v_pk_mul_f32 v[26:27], v[170:171], v[26:27]
    v_pk_mul_f32 v[28:29], v[172:173], v[28:29]
    v_pk_mul_f32 v[30:31], v[174:175], v[30:31]
    v_pk_mul_f32 v[32:33], v[176:177], v[32:33]
    v_pk_mul_f32 v[34:35], v[178:179], v[34:35]
    s_waitcnt lgkmcnt(0)
    s_barrier
    v_mfma_f32_16x16x32_bf16 v[68:71], a[128:131], a[0:3], 0
    ds_read_b64_tr_b16 v[52:53], v225 offset:16384
    ds_read_b64_tr_b16 v[54:55], v225 offset:16896
    v_cvt_pk_bf16_f32 v148, v4, v5
    v_mfma_f32_16x16x32_bf16 v[72:75], a[132:135], a[0:3], 0
    v_cvt_pk_bf16_f32 v149, v6, v7
    v_cvt_pk_bf16_f32 v150, v8, v9
    v_cvt_pk_bf16_f32 v151, v10, v11
    v_mfma_f32_16x16x32_bf16 v[76:79], a[128:131], a[4:7], 0
    v_cvt_pk_bf16_f32 v156, v20, v21
    v_cvt_pk_bf16_f32 v157, v22, v23
    v_mfma_f32_16x16x32_bf16 v[80:83], a[132:135], a[4:7], 0
    buffer_load_dwordx4 v219, s[20:23], s80 offen offset:0 lds
    v_mfma_f32_16x16x32_bf16 v[84:87], a[128:131], a[144:147], 0
    ds_read_b64_tr_b16 a[0:1], v226 offset:16384
    ds_read_b64_tr_b16 a[2:3], v226 offset:16896
    v_cvt_pk_bf16_f32 v158, v24, v25
    v_mfma_f32_16x16x32_bf16 v[88:91], a[132:135], a[144:147], 0
    v_cvt_pk_bf16_f32 v159, v26, v27
    ds_write_b128 v234, v[148:151] offset:0
    ds_write_b128 v234, v[156:159] offset:1024
    v_mfma_f32_16x16x32_bf16 v[92:95], a[128:131], a[148:151], 0
    ds_read_b64_tr_b16 v[132:133], v236 offset:0
    ds_read_b64_tr_b16 v[134:135], v237 offset:128
    v_mfma_f32_16x16x32_bf16 v[96:99], a[132:135], a[148:151], 0
    buffer_load_dwordx4 v220, s[20:23], s80 offen offset:1024 lds
    v_mfma_f32_16x16x32_bf16 v[68:71], a[136:139], a[8:11], v[68:71]
    ds_read_b64_tr_b16 a[4:5], v225 offset:20480
    ds_read_b64_tr_b16 a[6:7], v225 offset:20992
    ds_read_b64_tr_b16 v[140:141], v236 offset:512
    v_mfma_f32_16x16x32_bf16 v[72:75], a[140:143], a[8:11], v[72:75]
    ds_read_b64_tr_b16 v[142:143], v237 offset:640
    v_cvt_pk_bf16_f32 v152, v12, v13
    v_cvt_pk_bf16_f32 v153, v14, v15
    v_mfma_f32_16x16x32_bf16 v[76:79], a[136:139], a[12:15], v[76:79]
    v_cvt_pk_bf16_f32 v154, v16, v17
    v_cvt_pk_bf16_f32 v155, v18, v19
    v_mfma_f32_16x16x32_bf16 v[80:83], a[140:143], a[12:15], v[80:83]
    buffer_load_dwordx4 v221, s[20:23], s80 offen offset:2048 lds
    v_mfma_f32_16x16x32_bf16 v[84:87], a[136:139], a[152:155], v[84:87]
    ds_read_b64_tr_b16 a[128:129], v226 offset:20480
    ds_read_b64_tr_b16 a[130:131], v226 offset:20992
    v_cvt_pk_bf16_f32 v160, v28, v29
    v_mfma_f32_16x16x32_bf16 v[88:91], a[140:143], a[152:155], v[88:91]
    v_cvt_pk_bf16_f32 v161, v30, v31
    v_cvt_pk_bf16_f32 v162, v32, v33
    v_cvt_pk_bf16_f32 v163, v34, v35
    ds_write_b128 v234, v[152:155] offset:0
    v_mfma_f32_16x16x32_bf16 v[92:95], a[136:139], a[156:159], v[92:95]
    ds_write_b128 v234, v[160:163] offset:1024
    buffer_load_dwordx4 v222, s[20:23], s80 offen offset:3072 lds
    v_mfma_f32_16x16x32_bf16 v[96:99], a[140:143], a[156:159], v[96:99]
    s_add_u32 m0, s70, 98304
    v_mfma_f32_16x16x32_bf16 v[68:71], a[112:115], a[16:19], v[68:71]
    ds_read_b64_tr_b16 a[132:133], v225 offset:24576
    ds_read_b64_tr_b16 a[134:135], v225 offset:25088
    ds_read_b64_tr_b16 v[136:137], v236 offset:0
    v_mfma_f32_16x16x32_bf16 v[72:75], a[116:119], a[16:19], v[72:75]
    ds_read_b64_tr_b16 v[138:139], v237 offset:128
    ds_read_b64_tr_b16 v[144:145], v236 offset:512
    v_mfma_f32_16x16x32_bf16 v[76:79], a[112:115], a[20:23], v[76:79]
    ds_read_b64_tr_b16 v[146:147], v237 offset:640
    s_waitcnt lgkmcnt(14)
    buffer_store_dwordx4 v[132:135], v250, s[24:27], s89 offen offset:0 sc1
    v_mfma_f32_16x16x32_bf16 v[80:83], a[116:119], a[20:23], v[80:83]
    v_mfma_f32_16x16x32_bf16 v[84:87], a[112:115], a[160:163], v[84:87]
    ds_read_b64_tr_b16 a[144:145], v226 offset:24576
    ds_read_b64_tr_b16 a[146:147], v226 offset:25088
    v_mfma_f32_16x16x32_bf16 v[88:91], a[116:119], a[160:163], v[88:91]
    s_lshl_b32 s74, s36, 6
    v_lshrrev_b32 v194, 3, v0
    v_mfma_f32_16x16x32_bf16 v[92:95], a[112:115], a[164:167], v[92:95]
    v_mfma_f32_16x16x32_bf16 v[96:99], a[116:119], a[164:167], v[96:99]
    v_mfma_f32_16x16x32_bf16 v[68:71], a[120:123], a[24:27], v[68:71]
    ds_read_b64_tr_b16 a[148:149], v225 offset:28672
    ds_read_b64_tr_b16 a[150:151], v225 offset:29184
    v_mfma_f32_16x16x32_bf16 v[72:75], a[124:127], a[24:27], v[72:75]
    v_mfma_f32_16x16x32_bf16 v[76:79], a[120:123], a[28:31], v[76:79]
    v_mfma_f32_16x16x32_bf16 v[80:83], a[124:127], a[28:31], v[80:83]
    s_waitcnt vmcnt(5)
    s_atomic_add s66, s[24:25], s62 glc
    s_add_u32 s62, s62, 128
    s_waitcnt lgkmcnt(6)
    buffer_store_dwordx4 v[136:139], v250, s[24:27], s89 offen offset:1024 sc1
    v_and_b32 v168, 1, v194
    v_bfe_u32 v169, v194, 1, 3
    v_mfma_f32_16x16x32_bf16 v[84:87], a[120:123], a[168:171], v[84:87]
    ds_read_b64_tr_b16 a[8:9], v226 offset:28672
    ds_read_b64_tr_b16 a[10:11], v226 offset:29184
    v_mfma_f32_16x16x32_bf16 v[88:91], a[124:127], a[168:171], v[88:91]
    v_lshl_add_u32 v168, v168, 3, v169
    v_and_or_b32 v168, v194, 16, v168
    v_mfma_f32_16x16x32_bf16 v[92:95], a[120:123], a[172:175], v[92:95]
    v_mfma_f32_16x16x32_bf16 v[96:99], a[124:127], a[172:175], v[96:99]
    v_mfma_f32_16x16x32_bf16 v[68:71], v[36:39], a[32:35], v[68:71]
    ds_read_b64_tr_b16 a[12:13], v225 offset:32768
    ds_read_b64_tr_b16 a[14:15], v225 offset:33280
    v_mfma_f32_16x16x32_bf16 v[72:75], v[40:43], a[32:35], v[72:75]
    buffer_store_dwordx4 v[140:143], v250, s[24:27], s90 offen offset:0 sc1
    v_mfma_f32_16x16x32_bf16 v[76:79], v[36:39], a[36:39], v[76:79]
    v_add_u32 v168, s74, v168
    v_mfma_f32_16x16x32_bf16 v[80:83], v[40:43], a[36:39], v[80:83]
    v_mul_u32_u24 v168, 896, v168
    v_mfma_f32_16x16x32_bf16 v[84:87], v[36:39], a[176:179], v[84:87]
    ds_read_b64_tr_b16 a[136:137], v226 offset:32768
    ds_read_b64_tr_b16 a[138:139], v226 offset:33280
    v_mfma_f32_16x16x32_bf16 v[88:91], v[40:43], a[176:179], v[88:91]
    v_and_b32 v170, 7, v0
    s_lshl_b32 s74, s63, 7
    v_mfma_f32_16x16x32_bf16 v[92:95], v[36:39], a[180:183], v[92:95]
    v_mfma_f32_16x16x32_bf16 v[96:99], v[40:43], a[180:183], v[96:99]
    v_mfma_f32_16x16x32_bf16 v[68:71], v[44:47], a[40:43], v[68:71]
    ds_read_b64_tr_b16 a[140:141], v225 offset:36864
    ds_read_b64_tr_b16 a[142:143], v225 offset:37376
    v_mfma_f32_16x16x32_bf16 v[72:75], v[48:51], a[40:43], v[72:75]
    s_waitcnt lgkmcnt(12)
    buffer_store_dwordx4 v[144:147], v250, s[24:27], s90 offen offset:1024 sc1
    v_mfma_f32_16x16x32_bf16 v[76:79], v[44:47], a[44:47], v[76:79]
    v_lshl_add_u32 v169, v170, 3, s74
    v_mfma_f32_16x16x32_bf16 v[80:83], v[48:51], a[44:47], v[80:83]
    v_add_u32 v195, v168, v169
    v_mfma_f32_16x16x32_bf16 v[68:71], v[52:55], a[48:51], v[68:71]
    ds_read_b64_tr_b16 a[152:153], v226 offset:36864
    ds_read_b64_tr_b16 a[154:155], v226 offset:37376
    v_mfma_f32_16x16x32_bf16 v[72:75], a[0:3], a[48:51], v[72:75]
    v_mfma_f32_16x16x32_bf16 v[76:79], v[52:55], a[52:55], v[76:79]
    v_mfma_f32_16x16x32_bf16 v[80:83], a[0:3], a[52:55], v[80:83]
    s_waitcnt lgkmcnt(8)
    s_barrier
    buffer_load_dwordx4 v213, s[16:19], s41 offen offset:0 lds
    v_lshlrev_b32 v231, 1, v195
    v_and_b32 v168, 7, v194
    v_mfma_f32_16x16x32_bf16 v[68:71], a[4:7], a[56:59], v[68:71]
    ds_read_b64_tr_b16 a[156:157], v225 offset:40960
    ds_read_b64_tr_b16 a[158:159], v225 offset:41472
    v_mfma_f32_16x16x32_bf16 v[72:75], a[128:131], a[56:59], v[72:75]
    buffer_load_dwordx4 v214, s[16:19], s41 offen offset:1024 lds
    v_mfma_f32_16x16x32_bf16 v[76:79], a[4:7], a[60:63], v[76:79]
    v_xor_b32 v168, v168, v170
    v_mfma_f32_16x16x32_bf16 v[80:83], a[128:131], a[60:63], v[80:83]
    v_lshlrev_b32 v168, 4, v168
    v_mfma_f32_16x16x32_bf16 v[68:71], a[132:135], a[64:67], v[68:71]
    ds_read_b64_tr_b16 a[16:17], v226 offset:40960
    ds_read_b64_tr_b16 a[18:19], v226 offset:41472
    v_mfma_f32_16x16x32_bf16 v[72:75], a[144:147], a[64:67], v[72:75]
    buffer_load_dwordx4 v215, s[16:19], s41 offen offset:2048 lds
    v_mfma_f32_16x16x32_bf16 v[76:79], a[132:135], a[68:71], v[76:79]
    v_lshl_add_u32 v2, v194, 7, v168
    v_mfma_f32_16x16x32_bf16 v[80:83], a[144:147], a[68:71], v[80:83]
    v_add_u32 v2, 98304, v2
    v_mfma_f32_16x16x32_bf16 v[68:71], a[148:151], a[72:75], v[68:71]
    ds_read_b64_tr_b16 a[20:21], v225 offset:45056
    ds_read_b64_tr_b16 a[22:23], v225 offset:45568
    v_mfma_f32_16x16x32_bf16 v[72:75], a[8:11], a[72:75], v[72:75]
    buffer_load_dwordx4 v216, s[16:19], s41 offen offset:3072 lds
    v_mfma_f32_16x16x32_bf16 v[76:79], a[148:151], a[76:79], v[76:79]
    s_add_u32 m0, s70, 114688
    v_bfe_u32 v168, v206, 1, 3
    v_mfma_f32_16x16x32_bf16 v[80:83], a[8:11], a[76:79], v[80:83]
    v_bfe_u32 v169, v206, 4, 1
    s_waitcnt lgkmcnt(10)
    v_mfma_f32_16x16x32_bf16 v[68:71], a[12:15], a[80:83], v[68:71]
    ds_read_b64_tr_b16 a[112:113], v226 offset:45056
    ds_read_b64_tr_b16 a[114:115], v226 offset:45568
    v_mfma_f32_16x16x32_bf16 v[72:75], a[136:139], a[80:83], v[72:75]
    v_and_b32 v207, 15, v206
    v_xor_b32 v168, v168, v169
    v_mfma_f32_16x16x32_bf16 v[76:79], a[12:15], a[84:87], v[76:79]
    v_mfma_f32_16x16x32_bf16 v[80:83], a[136:139], a[84:87], v[80:83]
    s_waitcnt lgkmcnt(8)
    v_mfma_f32_16x16x32_bf16 v[68:71], a[140:143], a[88:91], v[68:71]
    v_xor_b32 v225, 64, v227
    v_xor_b32 v226, 64, v228
    v_mfma_f32_16x16x32_bf16 v[72:75], a[152:155], a[88:91], v[72:75]
    ds_read_b64_tr_b16 a[116:117], v227 offset:8192
    ds_read_b64_tr_b16 a[118:119], v227 offset:10240
    v_mfma_f32_16x16x32_bf16 v[76:79], a[140:143], a[92:95], v[76:79]
    ds_read_b64_tr_b16 a[160:161], v228 offset:8192
    ds_read_b64_tr_b16 a[162:163], v228 offset:10240
    v_lshlrev_b32 v168, 4, v168
    v_mfma_f32_16x16x32_bf16 v[80:83], a[152:155], a[92:95], v[80:83]
    v_lshl_add_u32 v168, v207, 7, v168
    s_waitcnt lgkmcnt(8)
    v_mfma_f32_16x16x32_bf16 v[68:71], a[156:159], a[96:99], v[68:71]
    ds_read_b64_tr_b16 a[164:165], v225 offset:8192
    ds_read_b64_tr_b16 a[166:167], v225 offset:10240
    v_mfma_f32_16x16x32_bf16 v[72:75], a[16:19], a[96:99], v[72:75]
    ds_read_b64_tr_b16 a[24:25], v226 offset:8192
    ds_read_b64_tr_b16 a[26:27], v226 offset:10240
    v_mfma_f32_16x16x32_bf16 v[76:79], a[156:159], a[100:103], v[76:79]
    v_mfma_f32_16x16x32_bf16 v[80:83], a[16:19], a[100:103], v[80:83]
    s_waitcnt lgkmcnt(8)
    s_barrier
    buffer_load_dwordx4 v213, s[16:19], s42 offen offset:0 lds
    v_lshl_add_u32 v168, v208, 13, v168
    s_mul_i32 s74, s68, 2112
    v_mfma_f32_16x16x32_bf16 v[68:71], a[20:23], a[104:107], v[68:71]
    ds_read_b128 a[28:31], v229 offset:0
    ds_read_b128 a[120:123], v230 offset:0
    v_mfma_f32_16x16x32_bf16 v[72:75], a[112:115], a[104:107], v[72:75]
    buffer_load_dwordx4 v214, s[16:19], s42 offen offset:1024 lds
    v_mfma_f32_16x16x32_bf16 v[76:79], a[20:23], a[108:111], v[76:79]
    v_xor_b32 v168, s74, v168
    v_mfma_f32_16x16x32_bf16 v[80:83], a[112:115], a[108:111], v[80:83]
    v_add_u32 v3, 49152, v168
    v_mfma_f32_16x16x32_bf16 v[84:87], v[44:47], a[184:187], v[84:87]
    ds_read_b128 a[124:127], v229 offset:2048
    ds_read_b128 a[168:171], v230 offset:2048
    v_cvt_pk_bf16_f32 v116, v68, v69
    v_cvt_pk_bf16_f32 v117, v70, v71
    v_mfma_f32_16x16x32_bf16 v[88:91], v[48:51], a[184:187], v[88:91]
    v_cvt_pk_bf16_f32 v118, v72, v73
    v_cvt_pk_bf16_f32 v119, v74, v75
    v_pk_max_i16 v116, v116, 0
    v_mfma_f32_16x16x32_bf16 v[92:95], v[44:47], a[188:191], v[92:95]
    v_pk_max_i16 v117, v117, 0
    v_pk_max_i16 v118, v118, 0
    v_pk_max_i16 v119, v119, 0
    v_mfma_f32_16x16x32_bf16 v[96:99], v[48:51], a[188:191], v[96:99]
    buffer_store_dwordx4 v[116:119], v249, s[24:27], s89 offen offset:0 sc1
    v_mfma_f32_16x16x32_bf16 v[84:87], v[52:55], a[192:195], v[84:87]
    ds_read_b64_tr_b16 a[172:173], v227 offset:16384
    ds_read_b64_tr_b16 a[174:175], v227 offset:18432
    ds_read_b64_tr_b16 a[32:33], v228 offset:16384
    ds_read_b64_tr_b16 a[34:35], v228 offset:18432
    v_mfma_f32_16x16x32_bf16 v[88:91], a[0:3], a[192:195], v[88:91]
    v_cvt_pk_bf16_f32 v120, v76, v77
    v_cvt_pk_bf16_f32 v121, v78, v79
    v_cvt_pk_bf16_f32 v122, v80, v81
    v_cvt_pk_bf16_f32 v123, v82, v83
    v_mfma_f32_16x16x32_bf16 v[92:95], v[52:55], a[196:199], v[92:95]
L_wm2:
L_is2:
    s_cbranch_execz L_wback
    v_pk_max_i16 v120, v120, 0
    v_pk_max_i16 v121, v121, 0
    v_pk_max_i16 v122, v122, 0
    v_pk_max_i16 v123, v123, 0
    v_mfma_f32_16x16x32_bf16 v[96:99], a[0:3], a[196:199], v[96:99]
    buffer_store_dwordx4 v[120:123], v249, s[24:27], s89 offen offset:1024 sc1
    v_mfma_f32_16x16x32_bf16 v[84:87], a[4:7], a[200:203], v[84:87]
    ds_read_b64_tr_b16 a[36:37], v225 offset:16384
    ds_read_b64_tr_b16 a[38:39], v225 offset:18432
    ds_read_b64_tr_b16 a[176:177], v226 offset:16384
    v_mfma_f32_16x16x32_bf16 v[88:91], a[128:131], a[200:203], v[88:91]
    ds_read_b64_tr_b16 a[178:179], v226 offset:18432
    v_mfma_f32_16x16x32_bf16 v[92:95], a[4:7], a[204:207], v[92:95]
    buffer_load_dwordx4 v215, s[16:19], s42 offen offset:2048 lds
    v_mfma_f32_16x16x32_bf16 v[96:99], a[128:131], a[204:207], v[96:99]
    v_xor_b32 v188, 2048, v3
    v_xor_b32 v189, 32, v3
    v_mfma_f32_16x16x32_bf16 v[84:87], a[132:135], a[208:211], v[84:87]
    buffer_load_dword v1, v255, s[24:27], s64 offen offset:0 sc1
    v_mfma_f32_16x16x32_bf16 v[88:91], a[144:147], a[208:211], v[88:91]
    v_mfma_f32_16x16x32_bf16 v[92:95], a[132:135], a[212:215], v[92:95]
    v_xor_b32 v190, 32, v188
    v_lshlrev_b32 v180, 16, v202
    v_mfma_f32_16x16x32_bf16 v[96:99], a[144:147], a[212:215], v[96:99]
    v_mfma_f32_16x16x32_bf16 v[84:87], a[148:151], a[216:219], v[84:87]
    buffer_load_dwordx4 v216, s[16:19], s42 offen offset:3072 lds
    v_mfma_f32_16x16x32_bf16 v[88:91], a[8:11], a[216:219], v[88:91]
    v_mfma_f32_16x16x32_bf16 v[92:95], a[148:151], a[220:223], v[92:95]
    s_add_u32 m0, s70, 131072
    v_and_b32 v181, 0xffff0000, v202
    v_mfma_f32_16x16x32_bf16 v[96:99], a[8:11], a[220:223], v[96:99]
    v_lshlrev_b32 v182, 16, v203
    v_mfma_f32_16x16x32_bf16 v[84:87], a[12:15], a[224:227], v[84:87]
    v_mfma_f32_16x16x32_bf16 v[88:91], a[136:139], a[224:227], v[88:91]
    v_mfma_f32_16x16x32_bf16 v[92:95], a[12:15], a[228:231], v[92:95]
    v_mfma_f32_16x16x32_bf16 v[96:99], a[136:139], a[228:231], v[96:99]
    s_waitcnt vmcnt(15) lgkmcnt(8)
    s_barrier
    buffer_load_dwordx4 v213, s[16:19], s43 offen offset:0 lds
    v_and_b32 v183, 0xffff0000, v203
    v_lshlrev_b32 v184, 16, v204
    v_mfma_f32_16x16x32_bf16 v[84:87], a[140:143], a[232:235], v[84:87]
    buffer_load_dwordx4 v214, s[16:19], s43 offen offset:1024 lds
    v_mfma_f32_16x16x32_bf16 v[88:91], a[152:155], a[232:235], v[88:91]
    v_mfma_f32_16x16x32_bf16 v[92:95], a[140:143], a[236:239], v[92:95]
    v_and_b32 v185, 0xffff0000, v204
    v_lshlrev_b32 v186, 16, v205
    v_mfma_f32_16x16x32_bf16 v[96:99], a[152:155], a[236:239], v[96:99]
    v_mfma_f32_16x16x32_bf16 v[84:87], a[156:159], a[240:243], v[84:87]
    buffer_load_dwordx4 v215, s[16:19], s43 offen offset:2048 lds
    v_mfma_f32_16x16x32_bf16 v[88:91], a[16:19], a[240:243], v[88:91]
    v_mfma_f32_16x16x32_bf16 v[92:95], a[156:159], a[244:247], v[92:95]
    v_and_b32 v187, 0xffff0000, v205
    s_lshl2_add_u32 s65, s65, s3
    v_mfma_f32_16x16x32_bf16 v[96:99], a[16:19], a[244:247], v[96:99]
    v_mfma_f32_16x16x32_bf16 v[84:87], a[20:23], a[248:251], v[84:87]
    v_mfma_f32_16x16x32_bf16 v[88:91], a[112:115], a[248:251], v[88:91]
    v_mfma_f32_16x16x32_bf16 v[92:95], a[20:23], a[252:255], v[92:95]
    v_mfma_f32_16x16x32_bf16 v[96:99], a[112:115], a[252:255], v[96:99]
    s_waitcnt vmcnt(14)
    s_atomic_add s67, s[24:25], s62 glc
    s_add_u32 s62, s62, 128
    buffer_load_dwordx4 v216, s[16:19], s43 offen offset:3072 lds
    s_lshl2_add_u32 s69, s69, s3
    v_mov_b32 v168, s65
    v_mfma_f32_16x16x32_bf16 v[36:39], a[116:119], v[100:103], 0
    v_cvt_pk_bf16_f32 v124, v84, v85
    v_cvt_pk_bf16_f32 v125, v86, v87
    v_cvt_pk_bf16_f32 v126, v88, v89
    v_mfma_f32_16x16x32_bf16 v[44:47], a[160:163], v[100:103], 0
    v_cvt_pk_bf16_f32 v127, v90, v91
    v_pk_max_i16 v124, v124, 0
    v_pk_max_i16 v125, v125, 0
    v_mfma_f32_16x16x32_bf16 v[52:55], a[164:167], v[100:103], 0
    v_pk_max_i16 v126, v126, 0
    v_pk_max_i16 v127, v127, 0
    v_mfma_f32_16x16x32_bf16 v[60:63], a[24:27], v[100:103], 0
    buffer_store_dwordx4 v[124:127], v249, s[24:27], s90 offen offset:0 sc1
    v_mfma_f32_16x16x32_bf16 v[40:43], a[116:119], v[104:107], 0
    v_cvt_pk_bf16_f32 v128, v92, v93
    v_cvt_pk_bf16_f32 v129, v94, v95
    v_cvt_pk_bf16_f32 v130, v96, v97
    v_mfma_f32_16x16x32_bf16 v[48:51], a[160:163], v[104:107], 0
    v_cvt_pk_bf16_f32 v131, v98, v99
    v_pk_max_i16 v128, v128, 0
    v_pk_max_i16 v129, v129, 0
    v_mfma_f32_16x16x32_bf16 v[56:59], a[164:167], v[104:107], 0
    v_pk_max_i16 v130, v130, 0
    v_pk_max_i16 v131, v131, 0
    v_mfma_f32_16x16x32_bf16 v[64:67], a[24:27], v[104:107], 0
    buffer_store_dwordx4 v[128:131], v249, s[24:27], s90 offen offset:1024 sc1
    v_mfma_f32_16x16x32_bf16 v[4:7], a[116:119], v[108:111], 0
    s_waitcnt vmcnt(7)
    v_cmp_eq_u32 vcc, 0, v1
    v_mfma_f32_16x16x32_bf16 v[12:15], a[160:163], v[108:111], 0
    v_mfma_f32_16x16x32_bf16 v[20:23], a[164:167], v[108:111], 0
    v_mfma_f32_16x16x32_bf16 v[28:31], a[24:27], v[108:111], 0
    s_cbranch_vccnz L_retry_hid0
L_ok_hid0:
    buffer_load_dwordx4 a[180:183], v248, s[24:27], s82 offen offset:0 sc1
    v_mov_b32 v169, s69
    v_cmp_eq_u32 vcc, 0, v208
    v_and_b32 v170, 3, v206
    v_add_u32 v191, s64, v255
    v_cndmask_b32 v168, v169, v168, vcc
    v_lshlrev_b32 v168, 9, v168
    v_cmp_eq_u32 vcc, 3, v170
    v_add_u32 v168, 196736, v168
    s_lshl_b32 s65, s65, 11
    v_cndmask_b32 v191, v191, v168, vcc
    v_mfma_f32_16x16x32_bf16 v[8:11], a[116:119], v[112:115], 0
    buffer_load_dwordx4 a[40:43], v248, s[24:27], s82 offen offset:1024 sc1
    v_mfma_f32_16x16x32_bf16 v[16:19], a[160:163], v[112:115], 0
    s_add_u32 s65, s65, 11665408
    v_mfma_f32_16x16x32_bf16 v[24:27], a[164:167], v[112:115], 0
    s_lshl_b32 s69, s69, 11
    s_add_u32 s69, s69, 11665408
    v_mfma_f32_16x16x32_bf16 v[32:35], a[24:27], v[112:115], 0
    s_add_u32 s74, s70, 147456
    v_mfma_f32_16x16x32_bf16 v[36:39], a[28:31], v[132:135], v[36:39]
    buffer_load_dwordx4 a[44:47], v248, s[24:27], s85 offen offset:0 sc1
    v_mfma_f32_16x16x32_bf16 v[44:47], a[120:123], v[132:135], v[44:47]
    v_add_u32 v192, s74, v248
    v_mfma_f32_16x16x32_bf16 v[52:55], a[124:127], v[132:135], v[52:55]
    v_xor_b32 v193, 8192, v192
    v_bfe_u32 v168, v206, 3, 1
    v_mfma_f32_16x16x32_bf16 v[60:63], a[168:171], v[132:135], v[60:63]
    v_lshl_add_u32 v168, v168, 4, v170
    v_mfma_f32_16x16x32_bf16 v[40:43], a[28:31], v[136:139], v[40:43]
    buffer_load_dwordx4 a[48:51], v248, s[24:27], s85 offen offset:1024 sc1
    v_mfma_f32_16x16x32_bf16 v[48:51], a[120:123], v[136:139], v[48:51]
    v_bfe_u32 v169, v206, 2, 1
    v_mfma_f32_16x16x32_bf16 v[56:59], a[124:127], v[136:139], v[56:59]
    v_lshl_add_u32 v168, v169, 2, v168
    v_lshl_add_u32 v168, v168, 7, s70
    v_mfma_f32_16x16x32_bf16 v[64:67], a[168:171], v[136:139], v[64:67]
    v_and_b32 v169, 7, v206
    v_mfma_f32_16x16x32_bf16 v[4:7], a[28:31], v[140:143], v[4:7]
    buffer_load_dwordx4 a[52:55], v248, s[24:27], s83 offen offset:0 sc1
    v_mfma_f32_16x16x32_bf16 v[12:15], a[120:123], v[140:143], v[12:15]
    v_lshrrev_b32 v170, 4, v206
    v_mfma_f32_16x16x32_bf16 v[20:23], a[124:127], v[140:143], v[20:23]
    v_xor_b32 v169, v169, v170
    v_lshl_add_u32 v168, v169, 4, v168
    v_mfma_f32_16x16x32_bf16 v[28:31], a[168:171], v[140:143], v[28:31]
    s_lshl_b32 s74, s68, 6
    v_mfma_f32_16x16x32_bf16 v[8:11], a[28:31], v[144:147], v[8:11]
    s_lshl_b32 s72, s68, 12
    s_sub_u32 s72, s72, 131072
    v_add_u32 v227, s72, v227
    v_add_u32 v228, s72, v228
    v_add_u32 v225, s72, v225
    v_mfma_f32_16x16x32_bf16 v[16:19], a[120:123], v[144:147], v[16:19]
    v_add_u32 v226, s72, v226
    ds_read_b64_tr_b16 a[56:57], v227 offset:0
    ds_read_b64_tr_b16 a[58:59], v227 offset:2048
    ds_read_b64_tr_b16 a[60:61], v228 offset:0
    v_mfma_f32_16x16x32_bf16 v[24:27], a[124:127], v[144:147], v[24:27]
    ds_read_b64_tr_b16 a[62:63], v228 offset:2048
    buffer_load_dwordx4 a[64:67], v248, s[24:27], s83 offen offset:1024 sc1
    v_mfma_f32_16x16x32_bf16 v[32:35], a[168:171], v[144:147], v[32:35]
    v_xor_b32 v209, s74, v168
    v_add_u32 v209, 98304, v209
    v_xor_b32 v210, 1024, v209
    v_xor_b32 v211, 64, v209
    s_waitcnt lgkmcnt(4)
    v_mfma_f32_16x16x32_bf16 v[36:39], a[172:175], v[116:119], v[36:39]
    ds_read_b64_tr_b16 a[68:69], v225 offset:0
    ds_read_b64_tr_b16 a[70:71], v225 offset:2048
    ds_read_b64_tr_b16 a[72:73], v226 offset:0
    v_mfma_f32_16x16x32_bf16 v[44:47], a[32:35], v[116:119], v[44:47]
    ds_read_b64_tr_b16 a[74:75], v226 offset:2048
    buffer_load_dwordx4 a[76:79], v248, s[24:27], s86 offen offset:0 sc1
    v_mfma_f32_16x16x32_bf16 v[52:55], a[36:39], v[116:119], v[52:55]
    v_xor_b32 v212, 1088, v209
    v_sub_f32 v200, 1.0, v238
    v_mfma_f32_16x16x32_bf16 v[60:63], a[176:179], v[116:119], v[60:63]
    v_cvt_pk_bf16_f32 v200, v200, v200
    v_lshlrev_b32 v200, 16, v200
    v_mfma_f32_16x16x32_bf16 v[40:43], a[172:175], v[120:123], v[40:43]
    buffer_load_dwordx4 a[80:83], v248, s[24:27], s86 offen offset:1024 sc1
    v_mfma_f32_16x16x32_bf16 v[48:51], a[32:35], v[120:123], v[48:51]
    v_max_f32 v200, 0x2b800000, v200
    v_mfma_f32_16x16x32_bf16 v[56:59], a[36:39], v[120:123], v[56:59]
    v_sub_f32 v201, 1.0, v239
    v_cvt_pk_bf16_f32 v201, v201, v201
    v_mfma_f32_16x16x32_bf16 v[64:67], a[176:179], v[120:123], v[64:67]
    v_lshlrev_b32 v201, 16, v201
    v_mfma_f32_16x16x32_bf16 v[4:7], a[172:175], v[124:127], v[4:7]
    buffer_load_dwordx4 a[84:87], v248, s[24:27], s84 offen offset:0 sc1
    v_mfma_f32_16x16x32_bf16 v[12:15], a[32:35], v[124:127], v[12:15]
    v_mfma_f32_16x16x32_bf16 v[20:23], a[36:39], v[124:127], v[20:23]
    v_max_f32 v201, 0x2b800000, v201
    v_mfma_f32_16x16x32_bf16 v[28:31], a[176:179], v[124:127], v[28:31]
    v_mfma_f32_16x16x32_bf16 v[8:11], a[172:175], v[128:131], v[8:11]
    ds_read_b64_tr_b16 a[88:89], v227 offset:16384
    ds_read_b64_tr_b16 a[90:91], v227 offset:18432
    ds_read_b64_tr_b16 a[92:93], v228 offset:16384
    v_mfma_f32_16x16x32_bf16 v[16:19], a[32:35], v[128:131], v[16:19]
    ds_read_b64_tr_b16 a[94:95], v228 offset:18432
    buffer_load_dwordx4 a[96:99], v248, s[24:27], s84 offen offset:1024 sc1
    v_mfma_f32_16x16x32_bf16 v[24:27], a[36:39], v[128:131], v[24:27]
    v_mfma_f32_16x16x32_bf16 v[32:35], a[176:179], v[128:131], v[32:35]
    buffer_load_dwordx4 a[100:103], v248, s[24:27], s87 offen offset:0 sc1
    s_waitcnt vmcnt(11)
    s_atomic_add s91, s[24:25], s62 glc
    s_add_u32 s62, s62, 128
    s_waitcnt vmcnt(10) lgkmcnt(4)
    v_mfma_f32_16x16x32_bf16 v[36:39], a[56:59], a[180:183], v[36:39]
    ds_read_b64_tr_b16 a[104:105], v225 offset:16384
    ds_read_b64_tr_b16 a[106:107], v225 offset:18432
    v_mfma_f32_16x16x32_bf16 v[44:47], a[60:63], a[180:183], v[44:47]
    ds_read_b64_tr_b16 a[108:109], v226 offset:16384
    ds_read_b64_tr_b16 a[110:111], v226 offset:18432
    v_mfma_f32_16x16x32_bf16 v[52:55], a[68:71], a[180:183], v[52:55]
    buffer_load_dwordx4 a[184:187], v248, s[24:27], s87 offen offset:1024 sc1
    v_mfma_f32_16x16x32_bf16 v[60:63], a[72:75], a[180:183], v[60:63]
    s_waitcnt vmcnt(10)
    v_mfma_f32_16x16x32_bf16 v[40:43], a[56:59], a[40:43], v[40:43]
    buffer_load_dwordx4 a[188:191], v248, s[24:27], s82 offen offset:2048 sc1
    v_mfma_f32_16x16x32_bf16 v[48:51], a[60:63], a[40:43], v[48:51]
    v_lshlrev_b32 v100, 16, v240
    v_mfma_f32_16x16x32_bf16 v[56:59], a[68:71], a[40:43], v[56:59]
    v_mul_f32 v100, v180, v100
    v_mul_f32 v100, v238, v100
    v_mfma_f32_16x16x32_bf16 v[64:67], a[72:75], a[40:43], v[64:67]
    v_and_b32 v101, 0xffff0000, v240
    s_waitcnt vmcnt(10)
    v_mfma_f32_16x16x32_bf16 v[4:7], a[56:59], a[44:47], v[4:7]
    buffer_load_dwordx4 a[0:3], v248, s[24:27], s82 offen offset:3072 sc1
    v_mfma_f32_16x16x32_bf16 v[12:15], a[60:63], a[44:47], v[12:15]
    v_mul_f32 v101, v181, v101
    v_mfma_f32_16x16x32_bf16 v[20:23], a[68:71], a[44:47], v[20:23]
    v_mul_f32 v101, v238, v101
    v_lshlrev_b32 v102, 16, v241
    v_mfma_f32_16x16x32_bf16 v[28:31], a[72:75], a[44:47], v[28:31]
    v_mul_f32 v102, v182, v102
    s_waitcnt vmcnt(10)
    v_mfma_f32_16x16x32_bf16 v[8:11], a[56:59], a[48:51], v[8:11]
    ds_read_b64_tr_b16 a[192:193], v227 offset:32768
    ds_read_b64_tr_b16 a[194:195], v227 offset:34816
    v_mfma_f32_16x16x32_bf16 v[16:19], a[60:63], a[48:51], v[16:19]
    ds_read_b64_tr_b16 a[196:197], v228 offset:32768
    ds_read_b64_tr_b16 a[198:199], v228 offset:34816
    v_mfma_f32_16x16x32_bf16 v[24:27], a[68:71], a[48:51], v[24:27]
    buffer_load_dwordx4 a[4:7], v248, s[24:27], s85 offen offset:2048 sc1
    v_mfma_f32_16x16x32_bf16 v[32:35], a[72:75], a[48:51], v[32:35]
    s_waitcnt vmcnt(10) lgkmcnt(4)
    v_mfma_f32_16x16x32_bf16 v[36:39], a[88:91], a[52:55], v[36:39]
    ds_read_b64_tr_b16 a[128:129], v225 offset:32768
    ds_read_b64_tr_b16 a[130:131], v225 offset:34816
    v_mfma_f32_16x16x32_bf16 v[44:47], a[92:95], a[52:55], v[44:47]
    ds_read_b64_tr_b16 a[200:201], v226 offset:32768
    ds_read_b64_tr_b16 a[202:203], v226 offset:34816
    v_mfma_f32_16x16x32_bf16 v[52:55], a[104:107], a[52:55], v[52:55]
    buffer_load_dwordx4 a[204:207], v248, s[24:27], s85 offen offset:3072 sc1
    v_mfma_f32_16x16x32_bf16 v[60:63], a[108:111], a[52:55], v[60:63]
    s_waitcnt vmcnt(10)
    v_mfma_f32_16x16x32_bf16 v[40:43], a[88:91], a[64:67], v[40:43]
    buffer_load_dword v1, v255, s[24:27], s64 offen offset:128 sc1
    v_mfma_f32_16x16x32_bf16 v[48:51], a[92:95], a[64:67], v[48:51]
    v_mul_f32 v102, v238, v102
    v_mfma_f32_16x16x32_bf16 v[56:59], a[104:107], a[64:67], v[56:59]
    v_and_b32 v103, 0xffff0000, v241
    v_mul_f32 v103, v183, v103
    v_mfma_f32_16x16x32_bf16 v[64:67], a[108:111], a[64:67], v[64:67]
    v_mul_f32 v103, v238, v103
    s_waitcnt vmcnt(10)
    v_mfma_f32_16x16x32_bf16 v[4:7], a[88:91], a[76:79], v[4:7]
    buffer_load_dwordx4 a[132:135], v248, s[24:27], s83 offen offset:2048 sc1
    v_mfma_f32_16x16x32_bf16 v[12:15], a[92:95], a[76:79], v[12:15]
    v_lshlrev_b32 v104, 16, v242
    v_mfma_f32_16x16x32_bf16 v[20:23], a[104:107], a[76:79], v[20:23]
    v_mul_f32 v104, v180, v104
    v_mul_f32 v104, v239, v104
    v_mfma_f32_16x16x32_bf16 v[28:31], a[108:111], a[76:79], v[28:31]
    v_and_b32 v105, 0xffff0000, v242
    s_waitcnt vmcnt(10)
    v_mfma_f32_16x16x32_bf16 v[8:11], a[88:91], a[80:83], v[8:11]
    ds_read_b64_tr_b16 a[144:145], v227 offset:4096
    ds_read_b64_tr_b16 a[146:147], v227 offset:6144
    v_mfma_f32_16x16x32_bf16 v[16:19], a[92:95], a[80:83], v[16:19]
    ds_read_b64_tr_b16 a[208:209], v228 offset:4096
    ds_read_b64_tr_b16 a[210:211], v228 offset:6144
    v_mfma_f32_16x16x32_bf16 v[24:27], a[104:107], a[80:83], v[24:27]
    buffer_load_dwordx4 a[212:215], v248, s[24:27], s83 offen offset:3072 sc1
    v_mfma_f32_16x16x32_bf16 v[32:35], a[108:111], a[80:83], v[32:35]
    s_waitcnt vmcnt(10) lgkmcnt(4)
    v_mfma_f32_16x16x32_bf16 v[36:39], a[192:195], a[84:87], v[36:39]
    ds_read_b64_tr_b16 a[148:149], v225 offset:4096
    ds_read_b64_tr_b16 a[150:151], v225 offset:6144
    v_mfma_f32_16x16x32_bf16 v[44:47], a[196:199], a[84:87], v[44:47]
    ds_read_b64_tr_b16 a[8:9], v226 offset:4096
    ds_read_b64_tr_b16 a[10:11], v226 offset:6144
    v_mfma_f32_16x16x32_bf16 v[52:55], a[128:131], a[84:87], v[52:55]
    buffer_load_dwordx4 a[216:219], v248, s[24:27], s86 offen offset:2048 sc1
    v_mfma_f32_16x16x32_bf16 v[60:63], a[200:203], a[84:87], v[60:63]
    s_waitcnt vmcnt(10)
    v_mfma_f32_16x16x32_bf16 v[40:43], a[192:195], a[96:99], v[40:43]
    buffer_load_dwordx4 a[220:223], v248, s[24:27], s86 offen offset:3072 sc1
    v_mfma_f32_16x16x32_bf16 v[48:51], a[196:199], a[96:99], v[48:51]
    v_mul_f32 v105, v181, v105
    v_mfma_f32_16x16x32_bf16 v[56:59], a[128:131], a[96:99], v[56:59]
    v_mul_f32 v105, v239, v105
    v_lshlrev_b32 v106, 16, v243
    v_mfma_f32_16x16x32_bf16 v[64:67], a[200:203], a[96:99], v[64:67]
    v_mul_f32 v106, v182, v106
    s_waitcnt vmcnt(10)
    v_mfma_f32_16x16x32_bf16 v[4:7], a[192:195], a[100:103], v[4:7]
    buffer_load_dwordx4 a[12:15], v248, s[24:27], s84 offen offset:2048 sc1
    v_mfma_f32_16x16x32_bf16 v[12:15], a[196:199], a[100:103], v[12:15]
    v_mul_f32 v106, v239, v106
    v_mfma_f32_16x16x32_bf16 v[20:23], a[128:131], a[100:103], v[20:23]
    v_and_b32 v107, 0xffff0000, v243
    v_mul_f32 v107, v183, v107
    v_mfma_f32_16x16x32_bf16 v[28:31], a[200:203], a[100:103], v[28:31]
    v_mul_f32 v107, v239, v107
    s_waitcnt vmcnt(10)
    v_mfma_f32_16x16x32_bf16 v[8:11], a[192:195], a[184:187], v[8:11]
    ds_read_b64_tr_b16 a[136:137], v227 offset:20480
    ds_read_b64_tr_b16 a[138:139], v227 offset:22528
    v_mfma_f32_16x16x32_bf16 v[16:19], a[196:199], a[184:187], v[16:19]
    ds_read_b64_tr_b16 a[224:225], v228 offset:20480
    ds_read_b64_tr_b16 a[226:227], v228 offset:22528
    v_mfma_f32_16x16x32_bf16 v[24:27], a[128:131], a[184:187], v[24:27]
    buffer_load_dwordx4 a[228:231], v248, s[24:27], s84 offen offset:3072 sc1
    v_mfma_f32_16x16x32_bf16 v[32:35], a[200:203], a[184:187], v[32:35]
    s_waitcnt vmcnt(10) lgkmcnt(4)
    v_mfma_f32_16x16x32_bf16 v[36:39], a[144:147], a[188:191], v[36:39]
    ds_read_b64_tr_b16 a[140:141], v225 offset:20480
    ds_read_b64_tr_b16 a[142:143], v225 offset:22528
    v_mfma_f32_16x16x32_bf16 v[44:47], a[208:211], a[188:191], v[44:47]
    ds_read_b64_tr_b16 a[152:153], v226 offset:20480
    ds_read_b64_tr_b16 a[154:155], v226 offset:22528
    v_mfma_f32_16x16x32_bf16 v[52:55], a[148:151], a[188:191], v[52:55]
    buffer_load_dwordx4 a[232:235], v248, s[24:27], s87 offen offset:2048 sc1
    v_mfma_f32_16x16x32_bf16 v[60:63], a[8:11], a[188:191], v[60:63]
    s_waitcnt vmcnt(10)
    v_mfma_f32_16x16x32_bf16 v[40:43], a[144:147], a[0:3], v[40:43]
    buffer_load_dwordx4 a[236:239], v248, s[24:27], s87 offen offset:3072 sc1
    v_mfma_f32_16x16x32_bf16 v[48:51], a[208:211], a[0:3], v[48:51]
    v_lshlrev_b32 v108, 16, v244
    v_mfma_f32_16x16x32_bf16 v[56:59], a[148:151], a[0:3], v[56:59]
    v_mul_f32 v108, v184, v108
    v_mul_f32 v108, v238, v108
    v_mfma_f32_16x16x32_bf16 v[64:67], a[8:11], a[0:3], v[64:67]
    v_and_b32 v109, 0xffff0000, v244
    s_waitcnt vmcnt(10)
    v_mfma_f32_16x16x32_bf16 v[4:7], a[144:147], a[4:7], v[4:7]
    s_waitcnt vmcnt(8)
    v_cmp_eq_u32 vcc, 0, v1
    v_mfma_f32_16x16x32_bf16 v[12:15], a[208:211], a[4:7], v[12:15]
    v_mfma_f32_16x16x32_bf16 v[20:23], a[148:151], a[4:7], v[20:23]
    v_mfma_f32_16x16x32_bf16 v[28:31], a[8:11], a[4:7], v[28:31]
    s_cbranch_vccnz L_retry_hid1
L_ok_hid1:
    buffer_load_dwordx4 a[156:159], v250, s[24:27], s82 offen offset:0 sc1
    v_mul_f32 v109, v185, v109
    v_mul_f32 v109, v238, v109
    v_lshlrev_b32 v110, 16, v245
    v_mul_f32 v110, v186, v110
    v_mfma_f32_16x16x32_bf16 v[8:11], a[144:147], a[204:207], v[8:11]
    ds_read_b64_tr_b16 a[16:17], v227 offset:36864
    ds_read_b64_tr_b16 a[18:19], v227 offset:38912
    ds_read_b64_tr_b16 a[240:241], v228 offset:36864
    v_mfma_f32_16x16x32_bf16 v[16:19], a[208:211], a[204:207], v[16:19]
    ds_read_b64_tr_b16 a[242:243], v228 offset:38912
    buffer_load_dwordx4 a[244:247], v250, s[24:27], s82 offen offset:1024 sc1
    v_mfma_f32_16x16x32_bf16 v[24:27], a[148:151], a[204:207], v[24:27]
    v_mfma_f32_16x16x32_bf16 v[32:35], a[8:11], a[204:207], v[32:35]
    buffer_load_dwordx4 a[20:23], v250, s[24:27], s83 offen offset:0 sc1
    s_waitcnt vmcnt(10) lgkmcnt(4)
    v_mfma_f32_16x16x32_bf16 v[36:39], a[136:139], a[132:135], v[36:39]
    ds_read_b64_tr_b16 a[112:113], v225 offset:36864
    ds_read_b64_tr_b16 a[114:115], v225 offset:38912
    v_mfma_f32_16x16x32_bf16 v[44:47], a[224:227], a[132:135], v[44:47]
    ds_read_b64_tr_b16 a[248:249], v226 offset:36864
    ds_read_b64_tr_b16 a[250:251], v226 offset:38912
    v_mfma_f32_16x16x32_bf16 v[52:55], a[140:143], a[132:135], v[52:55]
    buffer_load_dwordx4 a[252:255], v250, s[24:27], s83 offen offset:1024 sc1
    v_mfma_f32_16x16x32_bf16 v[60:63], a[152:155], a[132:135], v[60:63]
    s_waitcnt vmcnt(10)
    v_mfma_f32_16x16x32_bf16 v[40:43], a[136:139], a[212:215], v[40:43]
    buffer_load_dword v1, v191, s[24:27], 0 offen offset:256 sc1
    v_mfma_f32_16x16x32_bf16 v[48:51], a[224:227], a[212:215], v[48:51]
    v_mul_f32 v110, v238, v110
    v_mfma_f32_16x16x32_bf16 v[56:59], a[140:143], a[212:215], v[56:59]
    v_and_b32 v111, 0xffff0000, v245
    v_mul_f32 v111, v187, v111
    v_mfma_f32_16x16x32_bf16 v[64:67], a[152:155], a[212:215], v[64:67]
    v_mul_f32 v111, v238, v111
    s_waitcnt vmcnt(10)
    v_mfma_f32_16x16x32_bf16 v[4:7], a[136:139], a[216:219], v[4:7]
    buffer_load_dwordx4 a[116:119], v250, s[24:27], s84 offen offset:0 sc1
    v_mfma_f32_16x16x32_bf16 v[12:15], a[224:227], a[216:219], v[12:15]
    v_lshlrev_b32 v112, 16, v246
    v_mfma_f32_16x16x32_bf16 v[20:23], a[140:143], a[216:219], v[20:23]
    v_mul_f32 v112, v184, v112
    v_mul_f32 v112, v239, v112
    v_mfma_f32_16x16x32_bf16 v[28:31], a[152:155], a[216:219], v[28:31]
    v_and_b32 v113, 0xffff0000, v246
    s_waitcnt vmcnt(10)
    v_mfma_f32_16x16x32_bf16 v[8:11], a[136:139], a[220:223], v[8:11]
    ds_read_b128 a[160:163], v3 offset:16384
    ds_read_b128 a[164:167], v188 offset:16384
    v_mfma_f32_16x16x32_bf16 v[16:19], a[224:227], a[220:223], v[16:19]
    buffer_load_dwordx4 a[24:27], v250, s[24:27], s84 offen offset:1024 sc1
    v_mfma_f32_16x16x32_bf16 v[24:27], a[140:143], a[220:223], v[24:27]
    v_mfma_f32_16x16x32_bf16 v[32:35], a[152:155], a[220:223], v[32:35]
    v_mul_f32 v113, v185, v113
    s_waitcnt vmcnt(10) lgkmcnt(2)
    v_mfma_f32_16x16x32_bf16 v[36:39], a[16:19], a[12:15], v[36:39]
    ds_read_b128 a[28:31], v3 offset:20480
    ds_read_b128 a[120:123], v188 offset:20480
    v_mfma_f32_16x16x32_bf16 v[44:47], a[240:243], a[12:15], v[44:47]
    buffer_load_dwordx4 a[124:127], v250, s[24:27], s82 offen offset:2048 sc1
    v_mfma_f32_16x16x32_bf16 v[52:55], a[112:115], a[12:15], v[52:55]
    v_mfma_f32_16x16x32_bf16 v[60:63], a[248:251], a[12:15], v[60:63]
    v_mul_f32 v113, v239, v113
    s_waitcnt vmcnt(10)
    v_mfma_f32_16x16x32_bf16 v[40:43], a[16:19], a[228:231], v[40:43]
    ds_read_b128 a[168:171], v3 offset:32768
    ds_read_b128 a[172:175], v188 offset:32768
    v_mfma_f32_16x16x32_bf16 v[48:51], a[240:243], a[228:231], v[48:51]
    buffer_load_dwordx4 a[32:35], v250, s[24:27], s82 offen offset:3072 sc1
    v_mfma_f32_16x16x32_bf16 v[56:59], a[112:115], a[228:231], v[56:59]
    v_mfma_f32_16x16x32_bf16 v[64:67], a[248:251], a[228:231], v[64:67]
    v_lshlrev_b32 v114, 16, v247
    s_waitcnt vmcnt(10)
    v_mfma_f32_16x16x32_bf16 v[4:7], a[16:19], a[232:235], v[4:7]
    buffer_load_dwordx4 a[36:39], v250, s[24:27], s83 offen offset:2048 sc1
    v_mfma_f32_16x16x32_bf16 v[12:15], a[240:243], a[232:235], v[12:15]
    v_mul_f32 v114, v186, v114
    v_mfma_f32_16x16x32_bf16 v[20:23], a[112:115], a[232:235], v[20:23]
    v_mul_f32 v114, v239, v114
    v_and_b32 v115, 0xffff0000, v247
    v_mfma_f32_16x16x32_bf16 v[28:31], a[248:251], a[232:235], v[28:31]
    v_mul_f32 v115, v187, v115
    s_waitcnt vmcnt(10)
    v_mfma_f32_16x16x32_bf16 v[8:11], a[16:19], a[236:239], v[8:11]
    buffer_load_dwordx4 a[176:179], v250, s[24:27], s83 offen offset:3072 sc1
    v_mfma_f32_16x16x32_bf16 v[16:19], a[240:243], a[236:239], v[16:19]
    v_mfma_f32_16x16x32_bf16 v[24:27], a[112:115], a[236:239], v[24:27]
    v_mul_f32 v115, v239, v115
    v_mfma_f32_16x16x32_bf16 v[32:35], a[248:251], a[236:239], v[32:35]
    s_waitcnt vmcnt(10) lgkmcnt(2)
    v_mfma_f32_16x16x32_bf16 v[36:39], a[160:163], a[156:159], v[36:39]
    ds_read_b128 a[180:183], v3 offset:36864
    ds_read_b128 a[40:43], v188 offset:36864
    v_mfma_f32_16x16x32_bf16 v[44:47], a[164:167], a[156:159], v[44:47]
    buffer_load_dwordx4 a[44:47], v250, s[24:27], s84 offen offset:2048 sc1
    v_mfma_f32_16x16x32_bf16 v[52:55], a[28:31], a[156:159], v[52:55]
    v_mfma_f32_16x16x32_bf16 v[60:63], a[120:123], a[156:159], v[60:63]
    s_waitcnt vmcnt(10)
    v_mfma_f32_16x16x32_bf16 v[40:43], a[160:163], a[244:247], v[40:43]
    ds_read_b128 a[56:59], v3 offset:0
    ds_read_b128 a[60:63], v188 offset:0
    v_mfma_f32_16x16x32_bf16 v[48:51], a[164:167], a[244:247], v[48:51]
    buffer_load_dwordx4 a[68:71], v250, s[24:27], s84 offen offset:3072 sc1
    v_mfma_f32_16x16x32_bf16 v[56:59], a[28:31], a[244:247], v[56:59]
    v_mfma_f32_16x16x32_bf16 v[64:67], a[120:123], a[244:247], v[64:67]
    s_waitcnt vmcnt(10) lgkmcnt(2)
    v_mfma_f32_16x16x32_bf16 v[36:39], a[168:171], a[20:23], v[36:39]
    ds_read_b128 a[72:75], v3 offset:4096
    ds_read_b128 a[48:51], v188 offset:4096
    v_mfma_f32_16x16x32_bf16 v[44:47], a[172:175], a[20:23], v[44:47]
    s_waitcnt vmcnt(8)
    v_cmp_eq_u32 vcc, 0, v1
    v_mfma_f32_16x16x32_bf16 v[52:55], a[180:183], a[20:23], v[52:55]
    v_mfma_f32_16x16x32_bf16 v[60:63], a[40:43], a[20:23], v[60:63]
    s_cbranch_vccnz L_retry_hid2
L_ok_hid2:
    buffer_load_dwordx4 a[52:55], v249, s[24:27], s82 offen offset:0 sc1
    v_mfma_f32_16x16x32_bf16 v[40:43], a[168:171], a[252:255], v[40:43]
    ds_read_b128 a[64:67], v189 offset:16384
    ds_read_b128 a[76:79], v190 offset:16384
    v_mfma_f32_16x16x32_bf16 v[48:51], a[172:175], a[252:255], v[48:51]
    buffer_load_dwordx4 a[88:91], v249, s[24:27], s82 offen offset:1024 sc1
    v_mfma_f32_16x16x32_bf16 v[56:59], a[180:183], a[252:255], v[56:59]
    buffer_load_dwordx4 a[92:95], v249, s[24:27], s83 offen offset:0 sc1
    v_mfma_f32_16x16x32_bf16 v[64:67], a[40:43], a[252:255], v[64:67]
    s_waitcnt vmcnt(10) lgkmcnt(2)
    v_mfma_f32_16x16x32_bf16 v[36:39], a[56:59], a[116:119], v[36:39]
    ds_read_b128 a[104:107], v189 offset:20480
    ds_read_b128 a[108:111], v190 offset:20480
    v_mfma_f32_16x16x32_bf16 v[44:47], a[60:63], a[116:119], v[44:47]
    buffer_load_dwordx4 a[80:83], v249, s[24:27], s83 offen offset:1024 sc1
    v_mfma_f32_16x16x32_bf16 v[52:55], a[72:75], a[116:119], v[52:55]
    v_mfma_f32_16x16x32_bf16 v[60:63], a[48:51], a[116:119], v[60:63]
    s_waitcnt vmcnt(10)
    v_mfma_f32_16x16x32_bf16 v[40:43], a[56:59], a[24:27], v[40:43]
    ds_read_b128 a[84:87], v189 offset:32768
    ds_read_b128 a[96:99], v190 offset:32768
    v_mfma_f32_16x16x32_bf16 v[48:51], a[60:63], a[24:27], v[48:51]
    buffer_load_dwordx4 a[100:103], v249, s[24:27], s84 offen offset:0 sc1
    v_mfma_f32_16x16x32_bf16 v[56:59], a[72:75], a[24:27], v[56:59]
    v_mfma_f32_16x16x32_bf16 v[64:67], a[48:51], a[24:27], v[64:67]
    s_waitcnt vmcnt(10) lgkmcnt(2)
    v_mfma_f32_16x16x32_bf16 v[36:39], a[64:67], a[124:127], v[36:39]
    ds_read_b128 a[192:195], v189 offset:36864
    ds_read_b128 a[196:199], v190 offset:36864
    v_mfma_f32_16x16x32_bf16 v[44:47], a[76:79], a[124:127], v[44:47]
    buffer_load_dwordx4 a[128:131], v249, s[24:27], s84 offen offset:1024 sc1
    v_mfma_f32_16x16x32_bf16 v[52:55], a[104:107], a[124:127], v[52:55]
    v_mfma_f32_16x16x32_bf16 v[60:63], a[108:111], a[124:127], v[60:63]
    s_waitcnt vmcnt(10)
    v_mfma_f32_16x16x32_bf16 v[40:43], a[64:67], a[32:35], v[40:43]
    ds_read_b128 a[200:203], v189 offset:0
    ds_read_b128 a[184:187], v190 offset:0
    v_mfma_f32_16x16x32_bf16 v[48:51], a[76:79], a[32:35], v[48:51]
    buffer_load_dwordx4 a[188:191], v249, s[24:27], s82 offen offset:2048 sc1
    v_mfma_f32_16x16x32_bf16 v[56:59], a[104:107], a[32:35], v[56:59]
    v_mfma_f32_16x16x32_bf16 v[64:67], a[108:111], a[32:35], v[64:67]
    s_waitcnt vmcnt(10) lgkmcnt(2)
    v_mfma_f32_16x16x32_bf16 v[36:39], a[84:87], a[36:39], v[36:39]
    ds_read_b128 a[0:3], v189 offset:4096
    ds_read_b128 a[4:7], v190 offset:4096
    v_mfma_f32_16x16x32_bf16 v[44:47], a[96:99], a[36:39], v[44:47]
    buffer_load_dwordx4 a[144:147], v249, s[24:27], s82 offen offset:3072 sc1
    v_mfma_f32_16x16x32_bf16 v[52:55], a[192:195], a[36:39], v[52:55]
    v_mfma_f32_16x16x32_bf16 v[60:63], a[196:199], a[36:39], v[60:63]
    s_waitcnt vmcnt(10)
    v_mfma_f32_16x16x32_bf16 v[40:43], a[84:87], a[176:179], v[40:43]
    v_add_u32 v227, 0x18000, v227
    v_mfma_f32_16x16x32_bf16 v[48:51], a[96:99], a[176:179], v[48:51]
    v_mfma_f32_16x16x32_bf16 v[56:59], a[192:195], a[176:179], v[56:59]
    v_mfma_f32_16x16x32_bf16 v[64:67], a[196:199], a[176:179], v[64:67]
    s_barrier
    ds_read_b64_tr_b16 a[208:209], v227 offset:0
    ds_read_b64_tr_b16 a[210:211], v227 offset:2048
    v_add_u32 v228, 0x18000, v228
    ds_read_b64_tr_b16 a[148:149], v228 offset:0
    ds_read_b64_tr_b16 a[150:151], v228 offset:2048
    buffer_load_dwordx4 a[8:11], v249, s[24:27], s83 offen offset:2048 sc1
    s_waitcnt vmcnt(10) lgkmcnt(4)
    v_mfma_f32_16x16x32_bf16 v[36:39], a[200:203], a[44:47], v[36:39]
    v_add_u32 v225, 0x18000, v225
    ds_read_b64_tr_b16 a[204:205], v225 offset:0
    ds_read_b64_tr_b16 a[206:207], v225 offset:2048
    v_mfma_f32_16x16x32_bf16 v[44:47], a[184:187], a[44:47], v[44:47]
    v_add_u32 v226, 0x18000, v226
    ds_read_b64_tr_b16 a[132:133], v226 offset:0
    v_mfma_f32_16x16x32_bf16 v[52:55], a[0:3], a[44:47], v[52:55]
    ds_read_b64_tr_b16 a[134:135], v226 offset:2048
    buffer_load_dwordx4 a[212:215], v249, s[24:27], s83 offen offset:3072 sc1
    v_mfma_f32_16x16x32_bf16 v[60:63], a[4:7], a[44:47], v[60:63]
    s_waitcnt vmcnt(10)
    v_mfma_f32_16x16x32_bf16 v[40:43], a[200:203], a[68:71], v[40:43]
    ds_read_b64_tr_b16 a[216:217], v227 offset:16384
    ds_read_b64_tr_b16 a[218:219], v227 offset:18432
    v_mfma_f32_16x16x32_bf16 v[48:51], a[184:187], a[68:71], v[48:51]
    ds_read_b64_tr_b16 a[136:137], v228 offset:16384
    ds_read_b64_tr_b16 a[138:139], v228 offset:18432
    v_mfma_f32_16x16x32_bf16 v[56:59], a[0:3], a[68:71], v[56:59]
    buffer_load_dwordx4 a[224:227], v249, s[24:27], s84 offen offset:2048 sc1
    v_mfma_f32_16x16x32_bf16 v[64:67], a[4:7], a[68:71], v[64:67]
    s_waitcnt vmcnt(10) lgkmcnt(4)
    v_mfma_f32_16x16x32_bf16 v[36:39], a[208:211], a[52:55], v[36:39]
    ds_read_b64_tr_b16 a[140:141], v225 offset:16384
    ds_read_b64_tr_b16 a[142:143], v225 offset:18432
    v_mfma_f32_16x16x32_bf16 v[44:47], a[148:151], a[52:55], v[44:47]
    ds_read_b64_tr_b16 a[152:153], v226 offset:16384
    ds_read_b64_tr_b16 a[154:155], v226 offset:18432
    v_mfma_f32_16x16x32_bf16 v[52:55], a[204:207], a[52:55], v[52:55]
    buffer_load_dwordx4 a[220:223], v249, s[24:27], s84 offen offset:3072 sc1
    v_mfma_f32_16x16x32_bf16 v[60:63], a[132:135], a[52:55], v[60:63]
    s_waitcnt vmcnt(10)
    v_mfma_f32_16x16x32_bf16 v[40:43], a[208:211], a[88:91], v[40:43]
    ds_read_b64_tr_b16 a[12:13], v227 offset:32768
    ds_read_b64_tr_b16 a[14:15], v227 offset:34816
    v_mfma_f32_16x16x32_bf16 v[48:51], a[148:151], a[88:91], v[48:51]
    ds_read_b64_tr_b16 a[228:229], v228 offset:32768
    ds_read_b64_tr_b16 a[230:231], v228 offset:34816
    v_mfma_f32_16x16x32_bf16 v[56:59], a[204:207], a[88:91], v[56:59]
    buffer_load_dwordx4 a[232:235], v249, s[24:27], s85 offen offset:0 sc1
    v_mfma_f32_16x16x32_bf16 v[64:67], a[132:135], a[88:91], v[64:67]
    s_waitcnt vmcnt(10) lgkmcnt(4)
    v_mfma_f32_16x16x32_bf16 v[36:39], a[216:219], a[92:95], v[36:39]
L_wm3:
L_is3:
    s_cbranch_execz L_wback
    ds_read_b64_tr_b16 a[16:17], v225 offset:32768
    ds_read_b64_tr_b16 a[18:19], v225 offset:34816
    v_mfma_f32_16x16x32_bf16 v[44:47], a[136:139], a[92:95], v[44:47]
    ds_read_b64_tr_b16 a[240:241], v226 offset:32768
    ds_read_b64_tr_b16 a[242:243], v226 offset:34816
    v_mfma_f32_16x16x32_bf16 v[52:55], a[140:143], a[92:95], v[52:55]
    buffer_load_dwordx4 a[112:115], v249, s[24:27], s85 offen offset:1024 sc1
    v_mfma_f32_16x16x32_bf16 v[60:63], a[152:155], a[92:95], v[60:63]
    s_waitcnt vmcnt(10)
    v_mfma_f32_16x16x32_bf16 v[40:43], a[216:219], a[80:83], v[40:43]
    ds_read_b64_tr_b16 a[248:249], v227 offset:4096
    ds_read_b64_tr_b16 a[250:251], v227 offset:6144
    v_mfma_f32_16x16x32_bf16 v[48:51], a[136:139], a[80:83], v[48:51]
    ds_read_b64_tr_b16 a[236:237], v228 offset:4096
    ds_read_b64_tr_b16 a[238:239], v228 offset:6144
    v_mfma_f32_16x16x32_bf16 v[56:59], a[140:143], a[80:83], v[56:59]
    buffer_load_dwordx4 a[156:159], v249, s[24:27], s86 offen offset:0 sc1
    v_mfma_f32_16x16x32_bf16 v[64:67], a[152:155], a[80:83], v[64:67]
    s_waitcnt vmcnt(10) lgkmcnt(4)
    v_mfma_f32_16x16x32_bf16 v[36:39], a[12:15], a[100:103], v[36:39]
    ds_read_b64_tr_b16 a[160:161], v225 offset:4096
    ds_read_b64_tr_b16 a[162:163], v225 offset:6144
    v_mfma_f32_16x16x32_bf16 v[44:47], a[228:231], a[100:103], v[44:47]
    ds_read_b64_tr_b16 a[164:165], v226 offset:4096
    ds_read_b64_tr_b16 a[166:167], v226 offset:6144
    v_mfma_f32_16x16x32_bf16 v[52:55], a[16:19], a[100:103], v[52:55]
    buffer_load_dwordx4 a[28:31], v249, s[24:27], s86 offen offset:1024 sc1
    v_mfma_f32_16x16x32_bf16 v[60:63], a[240:243], a[100:103], v[60:63]
    s_waitcnt vmcnt(10)
    v_mfma_f32_16x16x32_bf16 v[40:43], a[12:15], a[128:131], v[40:43]
    ds_read_b64_tr_b16 a[120:121], v227 offset:20480
    ds_read_b64_tr_b16 a[122:123], v227 offset:22528
    v_mfma_f32_16x16x32_bf16 v[48:51], a[228:231], a[128:131], v[48:51]
    ds_read_b64_tr_b16 a[244:245], v228 offset:20480
    ds_read_b64_tr_b16 a[246:247], v228 offset:22528
    v_mfma_f32_16x16x32_bf16 v[56:59], a[16:19], a[128:131], v[56:59]
    buffer_load_dwordx4 a[20:23], v249, s[24:27], s87 offen offset:0 sc1
    v_mfma_f32_16x16x32_bf16 v[64:67], a[240:243], a[128:131], v[64:67]
    s_waitcnt vmcnt(10) lgkmcnt(4)
    v_mfma_f32_16x16x32_bf16 v[36:39], a[248:251], a[188:191], v[36:39]
    ds_read_b64_tr_b16 a[168:169], v225 offset:20480
    ds_read_b64_tr_b16 a[170:171], v225 offset:22528
    v_mfma_f32_16x16x32_bf16 v[44:47], a[236:239], a[188:191], v[44:47]
    ds_read_b64_tr_b16 a[172:173], v226 offset:20480
    ds_read_b64_tr_b16 a[174:175], v226 offset:22528
    v_mfma_f32_16x16x32_bf16 v[52:55], a[160:163], a[188:191], v[52:55]
    buffer_load_dwordx4 a[180:183], v249, s[24:27], s87 offen offset:1024 sc1
    v_mfma_f32_16x16x32_bf16 v[60:63], a[164:167], a[188:191], v[60:63]
    s_waitcnt vmcnt(10)
    v_mfma_f32_16x16x32_bf16 v[40:43], a[248:251], a[144:147], v[40:43]
    ds_read_b64_tr_b16 a[40:41], v227 offset:36864
    ds_read_b64_tr_b16 a[42:43], v227 offset:38912
    v_mfma_f32_16x16x32_bf16 v[48:51], a[236:239], a[144:147], v[48:51]
    ds_read_b64_tr_b16 a[252:253], v228 offset:36864
    ds_read_b64_tr_b16 a[254:255], v228 offset:38912
    v_mfma_f32_16x16x32_bf16 v[56:59], a[160:163], a[144:147], v[56:59]
    buffer_load_dwordx4 a[116:119], v249, s[24:27], s85 offen offset:2048 sc1
    v_mfma_f32_16x16x32_bf16 v[64:67], a[164:167], a[144:147], v[64:67]
    s_waitcnt vmcnt(10) lgkmcnt(4)
    v_mfma_f32_16x16x32_bf16 v[36:39], a[120:123], a[8:11], v[36:39]
    ds_read_b64_tr_b16 a[56:57], v225 offset:36864
    ds_read_b64_tr_b16 a[58:59], v225 offset:38912
    v_mfma_f32_16x16x32_bf16 v[44:47], a[244:247], a[8:11], v[44:47]
    ds_read_b64_tr_b16 a[60:61], v226 offset:36864
    ds_read_b64_tr_b16 a[62:63], v226 offset:38912
    v_mfma_f32_16x16x32_bf16 v[52:55], a[168:171], a[8:11], v[52:55]
    buffer_load_dwordx4 a[72:75], v249, s[24:27], s85 offen offset:3072 sc1
    v_mfma_f32_16x16x32_bf16 v[60:63], a[172:175], a[8:11], v[60:63]
    s_waitcnt vmcnt(10)
    v_mfma_f32_16x16x32_bf16 v[40:43], a[120:123], a[212:215], v[40:43]
    buffer_load_dwordx4 a[48:51], v249, s[24:27], s86 offen offset:2048 sc1
    v_mfma_f32_16x16x32_bf16 v[48:51], a[244:247], a[212:215], v[48:51]
    v_mfma_f32_16x16x32_bf16 v[56:59], a[168:171], a[212:215], v[56:59]
    v_mfma_f32_16x16x32_bf16 v[64:67], a[172:175], a[212:215], v[64:67]
    s_waitcnt vmcnt(10) lgkmcnt(0)
    v_mfma_f32_16x16x32_bf16 v[36:39], a[40:43], a[224:227], v[36:39]
    buffer_load_dwordx4 a[24:27], v249, s[24:27], s86 offen offset:3072 sc1
    v_mfma_f32_16x16x32_bf16 v[44:47], a[252:255], a[224:227], v[44:47]
    v_mfma_f32_16x16x32_bf16 v[52:55], a[56:59], a[224:227], v[52:55]
    v_mfma_f32_16x16x32_bf16 v[60:63], a[60:63], a[224:227], v[60:63]
    s_waitcnt vmcnt(10)
    v_mfma_f32_16x16x32_bf16 v[40:43], a[40:43], a[220:223], v[40:43]
    buffer_load_dwordx4 a[124:127], v249, s[24:27], s87 offen offset:2048 sc1
    v_mfma_f32_16x16x32_bf16 v[48:51], a[252:255], a[220:223], v[48:51]
    v_mfma_f32_16x16x32_bf16 v[56:59], a[56:59], a[220:223], v[56:59]
    v_mfma_f32_16x16x32_bf16 v[64:67], a[60:63], a[220:223], v[64:67]
    s_waitcnt vmcnt(10)
    v_mfma_f32_16x16x32_bf16 v[4:7], a[208:211], a[232:235], v[4:7]
    buffer_load_dwordx4 a[64:67], v249, s[24:27], s87 offen offset:3072 sc1
    v_mfma_f32_16x16x32_bf16 v[12:15], a[148:151], a[232:235], v[12:15]
    ds_write_b128 v192, v[44:47] offset:0
    v_mfma_f32_16x16x32_bf16 v[20:23], a[204:207], a[232:235], v[20:23]
    ds_write_b128 v192, v[48:51] offset:1024
    ds_write_b128 v192, v[60:63] offset:2048
    v_mfma_f32_16x16x32_bf16 v[28:31], a[132:135], a[232:235], v[28:31]
    ds_write_b128 v192, v[64:67] offset:3072
    s_waitcnt vmcnt(10)
    v_mfma_f32_16x16x32_bf16 v[8:11], a[208:211], a[112:115], v[8:11]
    buffer_load_dwordx4 a[76:79], v250, s[24:27], s85 offen offset:0 sc1
    v_mfma_f32_16x16x32_bf16 v[16:19], a[148:151], a[112:115], v[16:19]
    v_mfma_f32_16x16x32_bf16 v[24:27], a[204:207], a[112:115], v[24:27]
    v_mfma_f32_16x16x32_bf16 v[32:35], a[132:135], a[112:115], v[32:35]
    s_waitcnt lgkmcnt(0)
    s_barrier
    ds_read_b128 v[148:151], v193 offset:0
    ds_read_b128 v[152:155], v193 offset:1024
    ds_read_b128 v[156:159], v193 offset:2048
    ds_read_b128 v[160:163], v193 offset:3072
    s_waitcnt vmcnt(10)
    v_mfma_f32_16x16x32_bf16 v[4:7], a[216:219], a[156:159], v[4:7]
    buffer_load_dwordx4 a[104:107], v250, s[24:27], s85 offen offset:1024 sc1
    s_waitcnt lgkmcnt(3)
    v_add_f32 v148, v148, v36
    v_add_f32 v149, v149, v37
    v_mfma_f32_16x16x32_bf16 v[12:15], a[136:139], a[156:159], v[12:15]
    v_add_f32 v150, v150, v38
    v_add_f32 v151, v151, v39
    s_waitcnt lgkmcnt(2)
    v_add_f32 v152, v152, v40
    v_add_f32 v153, v153, v41
    v_add_f32 v154, v154, v42
    v_mfma_f32_16x16x32_bf16 v[20:23], a[140:143], a[156:159], v[20:23]
    v_add_f32 v155, v155, v43
    v_cvt_pk_bf16_f32 v116, v148, v149
    v_cvt_pk_bf16_f32 v117, v150, v151
    v_cvt_pk_bf16_f32 v118, v152, v153
    v_cvt_pk_bf16_f32 v119, v154, v155
    v_mfma_f32_16x16x32_bf16 v[28:31], a[152:155], a[156:159], v[28:31]
    v_min_u32 v116, -2, v116
    v_min_u32 v119, -2, v119
    s_waitcnt lgkmcnt(1)
    v_add_f32 v156, v156, v52
    v_add_f32 v157, v157, v53
    s_waitcnt vmcnt(10)
    v_mfma_f32_16x16x32_bf16 v[8:11], a[216:219], a[28:31], v[8:11]
    buffer_load_dwordx4 a[108:111], v250, s[24:27], s86 offen offset:0 sc1
    v_add_f32 v158, v158, v54
    v_add_f32 v159, v159, v55
    v_mfma_f32_16x16x32_bf16 v[16:19], a[136:139], a[28:31], v[16:19]
    s_waitcnt lgkmcnt(0)
    v_add_f32 v160, v160, v56
    v_add_f32 v161, v161, v57
    v_add_f32 v162, v162, v58
    v_add_f32 v163, v163, v59
    v_cvt_pk_bf16_f32 v120, v156, v157
    v_cvt_pk_bf16_f32 v121, v158, v159
    v_mfma_f32_16x16x32_bf16 v[24:27], a[140:143], a[28:31], v[24:27]
    v_cvt_pk_bf16_f32 v122, v160, v161
    v_cvt_pk_bf16_f32 v123, v162, v163
    v_min_u32 v120, -2, v120
    v_min_u32 v123, -2, v123
    buffer_store_dwordx4 v[116:119], v248, s[24:27], s65 offen offset:0 sc1
    v_mfma_f32_16x16x32_bf16 v[32:35], a[152:155], a[28:31], v[32:35]
    buffer_store_dwordx4 v[120:123], v248, s[24:27], s65 offen offset:1024 sc1
    s_waitcnt vmcnt(12)
    v_mfma_f32_16x16x32_bf16 v[4:7], a[12:15], a[20:23], v[4:7]
    buffer_load_dwordx4 a[32:35], v250, s[24:27], s86 offen offset:1024 sc1
    v_mfma_f32_16x16x32_bf16 v[12:15], a[228:231], a[20:23], v[12:15]
    v_mfma_f32_16x16x32_bf16 v[20:23], a[16:19], a[20:23], v[20:23]
    v_mfma_f32_16x16x32_bf16 v[28:31], a[240:243], a[20:23], v[28:31]
    s_waitcnt vmcnt(12)
    v_mfma_f32_16x16x32_bf16 v[8:11], a[12:15], a[180:183], v[8:11]
    buffer_load_dwordx4 a[36:39], v250, s[24:27], s87 offen offset:0 sc1
    v_mfma_f32_16x16x32_bf16 v[16:19], a[228:231], a[180:183], v[16:19]
    v_mfma_f32_16x16x32_bf16 v[24:27], a[16:19], a[180:183], v[24:27]
    v_mfma_f32_16x16x32_bf16 v[32:35], a[240:243], a[180:183], v[32:35]
    s_waitcnt vmcnt(12)
    v_mfma_f32_16x16x32_bf16 v[4:7], a[248:251], a[116:119], v[4:7]
    buffer_load_dwordx4 a[84:87], v250, s[24:27], s87 offen offset:1024 sc1
    v_mfma_f32_16x16x32_bf16 v[12:15], a[236:239], a[116:119], v[12:15]
    v_mfma_f32_16x16x32_bf16 v[20:23], a[160:163], a[116:119], v[20:23]
    v_mfma_f32_16x16x32_bf16 v[28:31], a[164:167], a[116:119], v[28:31]
    s_waitcnt vmcnt(12)
    v_mfma_f32_16x16x32_bf16 v[8:11], a[248:251], a[72:75], v[8:11]
    ds_read_b128 a[96:99], v3 offset:16384
    ds_read_b128 a[192:195], v188 offset:16384
    v_mfma_f32_16x16x32_bf16 v[16:19], a[236:239], a[72:75], v[16:19]
    buffer_load_dwordx4 a[196:199], v250, s[24:27], s85 offen offset:2048 sc1
    v_mfma_f32_16x16x32_bf16 v[24:27], a[160:163], a[72:75], v[24:27]
    v_mfma_f32_16x16x32_bf16 v[32:35], a[164:167], a[72:75], v[32:35]
    s_waitcnt vmcnt(12)
    v_mfma_f32_16x16x32_bf16 v[4:7], a[120:123], a[48:51], v[4:7]
    ds_read_b128 a[176:179], v3 offset:20480
    ds_read_b128 a[44:47], v188 offset:20480
    v_mfma_f32_16x16x32_bf16 v[12:15], a[244:247], a[48:51], v[12:15]
    buffer_load_dwordx4 a[200:203], v250, s[24:27], s85 offen offset:3072 sc1
    v_mfma_f32_16x16x32_bf16 v[20:23], a[168:171], a[48:51], v[20:23]
    v_mfma_f32_16x16x32_bf16 v[28:31], a[172:175], a[48:51], v[28:31]
    s_waitcnt vmcnt(12)
    v_mfma_f32_16x16x32_bf16 v[8:11], a[120:123], a[24:27], v[8:11]
    ds_read_b128 a[184:187], v3 offset:32768
    ds_read_b128 a[0:3], v188 offset:32768
    v_mfma_f32_16x16x32_bf16 v[16:19], a[244:247], a[24:27], v[16:19]
    buffer_load_dwordx4 a[4:7], v250, s[24:27], s86 offen offset:2048 sc1
    v_mfma_f32_16x16x32_bf16 v[24:27], a[168:171], a[24:27], v[24:27]
    v_mfma_f32_16x16x32_bf16 v[32:35], a[172:175], a[24:27], v[32:35]
    s_waitcnt vmcnt(12)
    v_mfma_f32_16x16x32_bf16 v[4:7], a[40:43], a[124:127], v[4:7]
    buffer_load_dwordx4 a[68:71], v250, s[24:27], s86 offen offset:3072 sc1
    v_mfma_f32_16x16x32_bf16 v[12:15], a[252:255], a[124:127], v[12:15]
    v_mfma_f32_16x16x32_bf16 v[20:23], a[56:59], a[124:127], v[20:23]
    v_mfma_f32_16x16x32_bf16 v[28:31], a[60:63], a[124:127], v[28:31]
    s_waitcnt vmcnt(12)
    v_mfma_f32_16x16x32_bf16 v[8:11], a[40:43], a[64:67], v[8:11]
    buffer_load_dwordx4 a[52:55], v250, s[24:27], s87 offen offset:2048 sc1
    v_mfma_f32_16x16x32_bf16 v[16:19], a[252:255], a[64:67], v[16:19]
    v_mfma_f32_16x16x32_bf16 v[24:27], a[56:59], a[64:67], v[24:27]
    v_mfma_f32_16x16x32_bf16 v[32:35], a[60:63], a[64:67], v[32:35]
    s_waitcnt vmcnt(12) lgkmcnt(2)
    v_mfma_f32_16x16x32_bf16 v[4:7], a[96:99], a[76:79], v[4:7]
    ds_read_b128 a[88:91], v3 offset:36864
    ds_read_b128 a[92:95], v188 offset:36864
    v_mfma_f32_16x16x32_bf16 v[12:15], a[192:195], a[76:79], v[12:15]
    buffer_load_dwordx4 a[80:83], v250, s[24:27], s87 offen offset:3072 sc1
    v_mfma_f32_16x16x32_bf16 v[20:23], a[176:179], a[76:79], v[20:23]
    v_mfma_f32_16x16x32_bf16 v[28:31], a[44:47], a[76:79], v[28:31]
    s_waitcnt vmcnt(12)
    v_mfma_f32_16x16x32_bf16 v[8:11], a[96:99], a[104:107], v[8:11]
    ds_read_b128 a[100:103], v3 offset:0
    ds_read_b128 a[128:131], v188 offset:0
    v_mfma_f32_16x16x32_bf16 v[16:19], a[192:195], a[104:107], v[16:19]
    v_mfma_f32_16x16x32_bf16 v[24:27], a[176:179], a[104:107], v[24:27]
    v_mfma_f32_16x16x32_bf16 v[32:35], a[44:47], a[104:107], v[32:35]
    s_waitcnt vmcnt(11) lgkmcnt(2)
    v_mfma_f32_16x16x32_bf16 v[4:7], a[184:187], a[108:111], v[4:7]
    ds_read_b128 a[188:191], v3 offset:4096
    ds_read_b128 a[144:147], v188 offset:4096
    v_mfma_f32_16x16x32_bf16 v[12:15], a[0:3], a[108:111], v[12:15]
    v_mfma_f32_16x16x32_bf16 v[20:23], a[88:91], a[108:111], v[20:23]
    v_mfma_f32_16x16x32_bf16 v[28:31], a[92:95], a[108:111], v[28:31]
    s_waitcnt vmcnt(8)
    v_mfma_f32_16x16x32_bf16 v[8:11], a[184:187], a[32:35], v[8:11]
    ds_read_b128 a[8:11], v189 offset:16384
    ds_read_b128 a[212:215], v190 offset:16384
    v_mfma_f32_16x16x32_bf16 v[16:19], a[0:3], a[32:35], v[16:19]
    v_mfma_f32_16x16x32_bf16 v[24:27], a[88:91], a[32:35], v[24:27]
    v_mfma_f32_16x16x32_bf16 v[32:35], a[92:95], a[32:35], v[32:35]
    s_waitcnt vmcnt(7) lgkmcnt(2)
    v_mfma_f32_16x16x32_bf16 v[4:7], a[100:103], a[36:39], v[4:7]
    ds_read_b128 a[224:227], v189 offset:20480
    ds_read_b128 a[220:223], v190 offset:20480
    v_mfma_f32_16x16x32_bf16 v[12:15], a[128:131], a[36:39], v[12:15]
    buffer_load_dwordx4 v[124:127], v248, s[24:27], s69 offen offset:0 sc1
    v_mfma_f32_16x16x32_bf16 v[20:23], a[188:191], a[36:39], v[20:23]
    buffer_load_dwordx4 v[128:131], v248, s[24:27], s69 offen offset:1024 sc1
    v_mfma_f32_16x16x32_bf16 v[28:31], a[144:147], a[36:39], v[28:31]
    s_waitcnt vmcnt(8)
    v_mfma_f32_16x16x32_bf16 v[8:11], a[100:103], a[84:87], v[8:11]
    ds_read_b128 a[232:235], v189 offset:32768
    ds_read_b128 a[208:211], v190 offset:32768
    v_mfma_f32_16x16x32_bf16 v[16:19], a[128:131], a[84:87], v[16:19]
    v_mfma_f32_16x16x32_bf16 v[24:27], a[188:191], a[84:87], v[24:27]
    v_mfma_f32_16x16x32_bf16 v[32:35], a[144:147], a[84:87], v[32:35]
    s_waitcnt vmcnt(7) lgkmcnt(2)
    v_mfma_f32_16x16x32_bf16 v[4:7], a[8:11], a[196:199], v[4:7]
    ds_read_b128 a[148:151], v189 offset:36864
    ds_read_b128 a[204:207], v190 offset:36864
    v_mfma_f32_16x16x32_bf16 v[12:15], a[212:215], a[196:199], v[12:15]
    v_mfma_f32_16x16x32_bf16 v[20:23], a[224:227], a[196:199], v[20:23]
    v_mfma_f32_16x16x32_bf16 v[28:31], a[220:223], a[196:199], v[28:31]
    s_waitcnt vmcnt(6)
    v_mfma_f32_16x16x32_bf16 v[8:11], a[8:11], a[200:203], v[8:11]
    ds_read_b128 a[132:135], v189 offset:0
    ds_read_b128 a[112:115], v190 offset:0
    v_mfma_f32_16x16x32_bf16 v[16:19], a[212:215], a[200:203], v[16:19]
    v_mfma_f32_16x16x32_bf16 v[24:27], a[224:227], a[200:203], v[24:27]
    v_mfma_f32_16x16x32_bf16 v[32:35], a[220:223], a[200:203], v[32:35]
    s_waitcnt vmcnt(5) lgkmcnt(2)
    v_mfma_f32_16x16x32_bf16 v[4:7], a[232:235], a[4:7], v[4:7]
    ds_read_b128 a[156:159], v189 offset:4096
    ds_read_b128 a[216:219], v190 offset:4096
    v_mfma_f32_16x16x32_bf16 v[12:15], a[208:211], a[4:7], v[12:15]
    v_mfma_f32_16x16x32_bf16 v[20:23], a[148:151], a[4:7], v[20:23]
    v_mfma_f32_16x16x32_bf16 v[28:31], a[204:207], a[4:7], v[28:31]
    s_waitcnt vmcnt(4)
    v_mfma_f32_16x16x32_bf16 v[8:11], a[232:235], a[68:71], v[8:11]
    v_mfma_f32_16x16x32_bf16 v[16:19], a[208:211], a[68:71], v[16:19]
    v_mfma_f32_16x16x32_bf16 v[24:27], a[148:151], a[68:71], v[24:27]
    v_mfma_f32_16x16x32_bf16 v[32:35], a[204:207], a[68:71], v[32:35]
    s_waitcnt vmcnt(3) lgkmcnt(0)
    v_mfma_f32_16x16x32_bf16 v[4:7], a[132:135], a[52:55], v[4:7]
    v_mfma_f32_16x16x32_bf16 v[12:15], a[112:115], a[52:55], v[12:15]
    v_mfma_f32_16x16x32_bf16 v[20:23], a[156:159], a[52:55], v[20:23]
    v_mfma_f32_16x16x32_bf16 v[28:31], a[216:219], a[52:55], v[28:31]
    s_waitcnt vmcnt(2)
    v_mfma_f32_16x16x32_bf16 v[8:11], a[132:135], a[80:83], v[8:11]
    s_mov_b32 s72, 57344
    s_nop 2
    ds_write_b128 v211, v[12:15] offset:0
    v_mfma_f32_16x16x32_bf16 v[16:19], a[112:115], a[80:83], v[16:19]
    v_mfma_f32_16x16x32_bf16 v[24:27], a[156:159], a[80:83], v[24:27]
    v_mfma_f32_16x16x32_bf16 v[32:35], a[216:219], a[80:83], v[32:35]
    s_nop 5
    ds_write_b128 v212, v[16:19] offset:0
    ds_write_b128 v211, v[28:31] offset:16384
    ds_write_b128 v212, v[32:35] offset:16384
    s_waitcnt vmcnt(0)
    v_max3_u32 v1, v124, v127, v128
    v_max_u32 v1, v1, v131
    v_cmp_eq_u32 vcc, -1, v1
    s_cbranch_vccnz L_retry_part
L_ok_part:
    v_lshlrev_b32 v132, 16, v124
    v_and_b32 v133, 0xffff0000, v124
    v_lshlrev_b32 v134, 16, v125
    v_and_b32 v135, 0xffff0000, v125
    v_lshlrev_b32 v136, 16, v126
    v_and_b32 v137, 0xffff0000, v126
    v_lshlrev_b32 v138, 16, v127
    v_and_b32 v139, 0xffff0000, v127
    v_lshlrev_b32 v140, 16, v128
    v_and_b32 v141, 0xffff0000, v128
    v_lshlrev_b32 v142, 16, v129
    v_and_b32 v143, 0xffff0000, v129
    v_lshlrev_b32 v144, 16, v130
    v_and_b32 v145, 0xffff0000, v130
    v_lshlrev_b32 v146, 16, v131
    v_and_b32 v147, 0xffff0000, v131
    v_pk_add_f32 v[4:5], v[4:5], v[132:133]
    v_pk_add_f32 v[6:7], v[6:7], v[134:135]
    v_pk_add_f32 v[8:9], v[8:9], v[136:137]
    v_pk_add_f32 v[10:11], v[10:11], v[138:139]
    ds_write_b128 v209, v[4:7] offset:0
    ds_write_b128 v210, v[8:11] offset:0
    v_pk_add_f32 v[20:21], v[20:21], v[140:141]
    v_pk_add_f32 v[22:23], v[22:23], v[142:143]
    v_pk_add_f32 v[24:25], v[24:25], v[144:145]
    v_pk_add_f32 v[26:27], v[26:27], v[146:147]
    ds_write_b128 v209, v[20:23] offset:16384
    ds_write_b128 v210, v[24:27] offset:16384
    s_waitcnt lgkmcnt(0)
    s_barrier
    ds_read_b128 v[148:151], v2 offset:0
    ds_read_b128 v[152:155], v2 offset:8192
    ds_read_b128 v[156:159], v2 offset:4096
    ds_read_b128 v[160:163], v2 offset:12288
    ds_read_b128 v[164:167], v2 offset:16384
    ds_read_b128 v[168:171], v2 offset:24576
    ds_read_b128 v[172:175], v2 offset:20480
    ds_read_b128 v[176:179], v2 offset:28672
    s_waitcnt lgkmcnt(6)
    v_pk_add_f32 v[148:149], v[148:149], v[152:153]
    v_pk_add_f32 v[150:151], v[150:151], v[154:155]
    v_pk_fma_f32 v[100:101], v[200:201], v[148:149], v[100:101] op_sel_hi:[0,1,1]
    v_pk_fma_f32 v[102:103], v[200:201], v[150:151], v[102:103] op_sel_hi:[0,1,1]
    buffer_store_dwordx4 v[100:103], v231, s[28:31], 0 offen offset:0 sc1
    s_waitcnt lgkmcnt(4)
    v_pk_add_f32 v[156:157], v[156:157], v[160:161]
    v_pk_add_f32 v[158:159], v[158:159], v[162:163]
    v_pk_fma_f32 v[104:105], v[200:201], v[156:157], v[104:105] op_sel:[1,0,0]
    v_pk_fma_f32 v[106:107], v[200:201], v[158:159], v[106:107] op_sel:[1,0,0]
    buffer_store_dwordx4 v[104:107], v231, s[28:31], s72 offen offset:0 sc1
    s_waitcnt lgkmcnt(2)
    v_pk_add_f32 v[164:165], v[164:165], v[168:169]
    v_pk_add_f32 v[166:167], v[166:167], v[170:171]
    v_pk_fma_f32 v[108:109], v[200:201], v[164:165], v[108:109] op_sel_hi:[0,1,1]
    v_pk_fma_f32 v[110:111], v[200:201], v[166:167], v[110:111] op_sel_hi:[0,1,1]
    buffer_store_dwordx4 v[108:111], v231, s[28:31], 0 offen offset:128 sc1
    s_waitcnt lgkmcnt(0)
    v_pk_add_f32 v[172:173], v[172:173], v[176:177]
    v_pk_add_f32 v[174:175], v[174:175], v[178:179]
    v_pk_fma_f32 v[112:113], v[200:201], v[172:173], v[112:113] op_sel:[1,0,0]
    v_pk_fma_f32 v[114:115], v[200:201], v[174:175], v[114:115] op_sel:[1,0,0]
    buffer_store_dwordx4 v[112:115], v231, s[28:31], s72 offen offset:128 sc1
    s_endpgm
L_retry_ready:
    s_mov_b32 s73, 0x40000
L_spin_ready:
    global_load_dword v1, v253, s[46:47] sc1
    s_waitcnt vmcnt(0)
    v_cmp_gt_u32 vcc, 32, v1
    s_nop 3
    s_cbranch_vccz L_ok_ready
    s_sub_u32 s73, s73, 1
    s_cbranch_scc0 L_spin_ready
    s_branch L_ok_ready
L_retry_fin:
    s_mov_b32 s73, 0x40000
L_spin_fin:
    buffer_load_dwordx2 v[162:163], v251, s[32:35], 0 offen offset:2048 sc1
    buffer_load_dwordx2 v[160:161], v251, s[32:35], 0 offen offset:1792 sc1
    buffer_load_dwordx2 v[158:159], v251, s[32:35], 0 offen offset:1536 sc1
    buffer_load_dwordx2 v[156:157], v251, s[32:35], 0 offen offset:1280 sc1
    buffer_load_dwordx2 v[154:155], v251, s[32:35], 0 offen offset:1024 sc1
    buffer_load_dwordx2 v[152:153], v251, s[32:35], 0 offen offset:768 sc1
    buffer_load_dwordx2 v[150:151], v251, s[32:35], 0 offen offset:512 sc1
    buffer_load_dwordx2 v[148:149], v251, s[32:35], 0 offen offset:256 sc1
    buffer_load_dwordx4 v[164:167], v233, s[24:27], s75 offen offset:0 sc1
    buffer_load_dwordx4 v[168:171], v233, s[24:27], s75 offen offset:16 sc1
    buffer_load_dwordx4 v[172:175], v233, s[24:27], s75 offen offset:32 sc1
    buffer_load_dwordx4 v[176:179], v233, s[24:27], s75 offen offset:48 sc1
    buffer_load_dword v238, v232, s[24:27], s75 offen offset:0 sc1
    buffer_load_dword v239, v232, s[24:27], s75 offen offset:128 sc1
    s_waitcnt vmcnt(0)
    v_max3_u32 v194, v148, v149, v150
    v_max3_u32 v194, v194, v151, v152
    v_max3_u32 v194, v194, v153, v154
    v_max3_u32 v194, v194, v155, v156
    v_max3_u32 v194, v194, v157, v158
    v_max3_u32 v194, v194, v159, v160
    v_max3_u32 v194, v194, v161, v162
    v_max3_u32 v194, v194, v163, v164
    v_max3_u32 v194, v194, v165, v166
    v_max3_u32 v194, v194, v167, v168
    v_max3_u32 v194, v194, v169, v170
    v_max3_u32 v194, v194, v171, v172
    v_max3_u32 v194, v194, v173, v174
    v_max3_u32 v194, v194, v175, v176
    v_max3_u32 v194, v194, v177, v178
    v_max3_u32 v194, v194, v179, v238
    v_max_u32 v194, v194, v239
    v_cmp_eq_u32 vcc, -1, v194
    s_nop 3
    s_cbranch_vccz L_ok_fin
    s_sub_u32 s73, s73, 1
    s_cbranch_scc0 L_spin_fin
    s_branch L_ok_fin
L_retry_hid0:
    s_mov_b32 s73, 0x40000
L_spin_hid0:
    buffer_load_dword v1, v255, s[24:27], s64 offen offset:0 sc1
    s_waitcnt vmcnt(0)
    v_cmp_eq_u32 vcc, 0, v1
    s_nop 3
    s_cbranch_vccz L_ok_hid0
    s_sub_u32 s73, s73, 1
    s_cbranch_scc0 L_spin_hid0
    s_branch L_ok_hid0
L_retry_hid1:
    s_mov_b32 s73, 0x40000
L_spin_hid1:
    buffer_load_dword v1, v255, s[24:27], s64 offen offset:128 sc1
    s_waitcnt vmcnt(0)
    v_cmp_eq_u32 vcc, 0, v1
    s_nop 3
    s_cbranch_vccz L_ok_hid1
    s_sub_u32 s73, s73, 1
    s_cbranch_scc0 L_spin_hid1
    s_branch L_ok_hid1
L_retry_hid2:
    s_mov_b32 s73, 0x40000
L_spin_hid2:
    buffer_load_dword v1, v191, s[24:27], 0 offen offset:256 sc1
    s_waitcnt vmcnt(0)
    v_cmp_eq_u32 vcc, 0, v1
    s_nop 3
    s_cbranch_vccz L_ok_hid2
    s_sub_u32 s73, s73, 1
    s_cbranch_scc0 L_spin_hid2
    s_branch L_ok_hid2
L_retry_part:
    s_mov_b32 s73, 0x40000
L_spin_part:
    buffer_load_dwordx4 v[124:127], v248, s[24:27], s69 offen offset:0 sc1
    buffer_load_dwordx4 v[128:131], v248, s[24:27], s69 offen offset:1024 sc1
    s_waitcnt vmcnt(0)
    v_max3_u32 v1, v124, v127, v128
    v_max_u32 v1, v1, v131
    v_cmp_eq_u32 vcc, -1, v1
    s_nop 3
    s_cbranch_vccz L_ok_part
    s_sub_u32 s73, s73, 1
    s_cbranch_scc0 L_spin_part
    s_branch L_ok_part
L_helper2:
    v_mul_u32_u24 v160, 293, v0
    v_lshrrev_b32 v160, 11, v160
    v_mul_u32_u24 v161, 7, v160
    v_sub_u32 v161, v0, v161
    v_lshrrev_b32 v163, 2, v0
    v_mul_u32_u24 v163, 896, v163
    v_and_b32 v164, 3, v0
    v_lshl_add_u32 v163, v164, 7, v163
    v_cndmask_b32 v163, v155, v163, vcc
    v_cmp_gt_u32 vcc, 196, v0
    v_mul_u32_u24 v162, 3584, v160
    v_lshl_add_u32 v162, v161, 8, v162
    v_cndmask_b32 v162, v155, v162, vcc
    s_add_u32 s87, s83, 0
    s_and_b32 s87, s87, 3
    s_add_u32 s87, s87, s84
    s_mul_i32 s85, s87, 100352
    s_mul_i32 s89, s82, 1792
    s_add_u32 s85, s85, s89
    buffer_load_dword v168, v162, s[12:15], s85 offen offset:0
    s_waitcnt vmcnt(1) lgkmcnt(0)
    s_barrier
    s_cmp_lg_u32 s3, 0
    s_cbranch_scc1 L_h2
    s_mov_b32 s88, 1
    s_atomic_add s88, s[46:47], 0 glc
L_h2:
    s_lshl2_add_u32 s85, s81, s3
    s_lshl_b32 s85, s85, 4
    v_lshrrev_b32 v88, 3, v206
    v_add_u32 v89, s85, v88
    v_mul_u32_u24 v89, 896, v89
    v_and_b32 v98, 7, v206
    v_lshlrev_b32 v90, 4, v98
    v_add_u32 v89, v89, v90
    s_mov_b32 s6, 1835008
    s_mov_b32 s7, 0x20000
    s_movk_i32 s85, 7168
    global_load_dwordx4 v[60:63], v90, s[44:45] offset:0
    global_load_dwordx4 v[64:67], v90, s[44:45] offset:128
    global_load_dwordx4 v[68:71], v90, s[44:45] offset:256
    global_load_dwordx4 v[72:75], v90, s[44:45] offset:384
    global_load_dwordx4 v[76:79], v90, s[44:45] offset:512
    global_load_dwordx4 v[80:83], v90, s[44:45] offset:640
    global_load_dwordx4 v[84:87], v90, s[44:45] offset:768
    buffer_load_dwordx4 v[4:7], v89, s[4:7], 0 offen offset:0
    buffer_load_dwordx4 v[8:11], v89, s[4:7], s85 offen offset:0
    buffer_load_dwordx4 v[12:15], v89, s[4:7], 0 offen offset:128
    buffer_load_dwordx4 v[16:19], v89, s[4:7], s85 offen offset:128
    buffer_load_dwordx4 v[20:23], v89, s[4:7], 0 offen offset:256
    buffer_load_dwordx4 v[24:27], v89, s[4:7], s85 offen offset:256
    buffer_load_dwordx4 v[28:31], v89, s[4:7], 0 offen offset:384
    buffer_load_dwordx4 v[32:35], v89, s[4:7], s85 offen offset:384
    buffer_load_dwordx4 v[36:39], v89, s[4:7], 0 offen offset:512
    buffer_load_dwordx4 v[40:43], v89, s[4:7], s85 offen offset:512
    buffer_load_dwordx4 v[44:47], v89, s[4:7], 0 offen offset:640
    buffer_load_dwordx4 v[48:51], v89, s[4:7], s85 offen offset:640
    buffer_load_dwordx4 v[52:55], v89, s[4:7], 0 offen offset:768
    buffer_load_dwordx4 v[56:59], v89, s[4:7], s85 offen offset:768
    s_add_u32 s87, s83, 0
    s_and_b32 s87, s87, 3
    s_add_u32 s87, s87, s84
    s_mul_i32 s85, s87, 100352
    s_mul_i32 s89, s82, 1792
    s_add_u32 s85, s85, s89
    buffer_load_dword v169, v162, s[12:15], s85 offen offset:128
    s_add_u32 s87, s83, 0
    s_and_b32 s87, s87, 3
    s_add_u32 s87, s87, s84
    s_mul_i32 s85, s87, 28
    v_add_u32 v164, s85, v160
    v_and_b32 v165, 0xffffffc0, v164
    v_add_u32 v164, v164, v165
    v_mul_u32_u24 v164, 896, v164
    v_lshl_add_u32 v164, v161, 7, v164
    v_cndmask_b32 v164, v155, v164, vcc
    s_mul_i32 s85, s82, 802816
    s_add_u32 s85, s85, 0
    buffer_load_dword v170, v164, s[16:19], s85 offen
    s_add_u32 s87, s83, 0
    s_and_b32 s87, s87, 3
    s_add_u32 s87, s87, s84
    s_mul_i32 s85, s87, 25088
    s_mul_i32 s89, s82, 384
    s_add_u32 s85, s85, s89
    buffer_load_dword v171, v163, s[20:23], s85 offen
    buffer_load_dword v172, v163, s[8:11], s85 offen
    v_lshl_add_u32 v99, v88, 1, 0
    v_mov_b32 v94, 0
    v_mov_b32 v95, 0
    v_mov_b32 v96, 0x3f803f80
    s_waitcnt vmcnt(4)
    v_lshlrev_b32 v88, 16, v60
    v_and_b32 v89, 0xffff0000, v60
    v_lshlrev_b32 v90, 16, v4
    v_and_b32 v91, 0xffff0000, v4
    v_lshlrev_b32 v92, 16, v8
    v_and_b32 v93, 0xffff0000, v8
    v_pk_mul_f32 v[90:91], v[90:91], v[88:89]
    v_pk_mul_f32 v[92:93], v[92:93], v[88:89]
    v_cvt_pk_bf16_f32 v90, v90, v91
    v_cvt_pk_bf16_f32 v92, v92, v93
    v_dot2c_f32_bf16 v94, v90, v96
    v_dot2c_f32_bf16 v95, v92, v96
    v_lshlrev_b32 v88, 16, v61
    v_and_b32 v89, 0xffff0000, v61
    v_lshlrev_b32 v90, 16, v5
    v_and_b32 v91, 0xffff0000, v5
    v_lshlrev_b32 v92, 16, v9
    v_and_b32 v93, 0xffff0000, v9
    v_pk_mul_f32 v[90:91], v[90:91], v[88:89]
    v_pk_mul_f32 v[92:93], v[92:93], v[88:89]
    v_cvt_pk_bf16_f32 v90, v90, v91
    v_cvt_pk_bf16_f32 v92, v92, v93
    v_dot2c_f32_bf16 v94, v90, v96
    v_dot2c_f32_bf16 v95, v92, v96
    v_lshlrev_b32 v88, 16, v62
    v_and_b32 v89, 0xffff0000, v62
    v_lshlrev_b32 v90, 16, v6
    v_and_b32 v91, 0xffff0000, v6
    v_lshlrev_b32 v92, 16, v10
    v_and_b32 v93, 0xffff0000, v10
    v_pk_mul_f32 v[90:91], v[90:91], v[88:89]
    v_pk_mul_f32 v[92:93], v[92:93], v[88:89]
    v_cvt_pk_bf16_f32 v90, v90, v91
    v_cvt_pk_bf16_f32 v92, v92, v93
    v_dot2c_f32_bf16 v94, v90, v96
    v_dot2c_f32_bf16 v95, v92, v96
    v_lshlrev_b32 v88, 16, v63
    v_and_b32 v89, 0xffff0000, v63
    v_lshlrev_b32 v90, 16, v7
    v_and_b32 v91, 0xffff0000, v7
    v_lshlrev_b32 v92, 16, v11
    v_and_b32 v93, 0xffff0000, v11
    v_pk_mul_f32 v[90:91], v[90:91], v[88:89]
    v_pk_mul_f32 v[92:93], v[92:93], v[88:89]
    v_cvt_pk_bf16_f32 v90, v90, v91
    v_cvt_pk_bf16_f32 v92, v92, v93
    v_dot2c_f32_bf16 v94, v90, v96
    v_dot2c_f32_bf16 v95, v92, v96
    v_lshlrev_b32 v88, 16, v64
    v_and_b32 v89, 0xffff0000, v64
    v_lshlrev_b32 v90, 16, v12
    v_and_b32 v91, 0xffff0000, v12
    v_lshlrev_b32 v92, 16, v16
    v_and_b32 v93, 0xffff0000, v16
    v_pk_mul_f32 v[90:91], v[90:91], v[88:89]
    v_pk_mul_f32 v[92:93], v[92:93], v[88:89]
    v_cvt_pk_bf16_f32 v90, v90, v91
    v_cvt_pk_bf16_f32 v92, v92, v93
    v_dot2c_f32_bf16 v94, v90, v96
    v_dot2c_f32_bf16 v95, v92, v96
    v_lshlrev_b32 v88, 16, v65
    v_and_b32 v89, 0xffff0000, v65
    v_lshlrev_b32 v90, 16, v13
    v_and_b32 v91, 0xffff0000, v13
    v_lshlrev_b32 v92, 16, v17
    v_and_b32 v93, 0xffff0000, v17
    v_pk_mul_f32 v[90:91], v[90:91], v[88:89]
    v_pk_mul_f32 v[92:93], v[92:93], v[88:89]
    v_cvt_pk_bf16_f32 v90, v90, v91
    v_cvt_pk_bf16_f32 v92, v92, v93
    v_dot2c_f32_bf16 v94, v90, v96
    v_dot2c_f32_bf16 v95, v92, v96
    v_lshlrev_b32 v88, 16, v66
    v_and_b32 v89, 0xffff0000, v66
    v_lshlrev_b32 v90, 16, v14
    v_and_b32 v91, 0xffff0000, v14
    v_lshlrev_b32 v92, 16, v18
    v_and_b32 v93, 0xffff0000, v18
    v_pk_mul_f32 v[90:91], v[90:91], v[88:89]
    v_pk_mul_f32 v[92:93], v[92:93], v[88:89]
    v_cvt_pk_bf16_f32 v90, v90, v91
    v_cvt_pk_bf16_f32 v92, v92, v93
    v_dot2c_f32_bf16 v94, v90, v96
    v_dot2c_f32_bf16 v95, v92, v96
    v_lshlrev_b32 v88, 16, v67
    v_and_b32 v89, 0xffff0000, v67
    v_lshlrev_b32 v90, 16, v15
    v_and_b32 v91, 0xffff0000, v15
    v_lshlrev_b32 v92, 16, v19
    v_and_b32 v93, 0xffff0000, v19
    v_pk_mul_f32 v[90:91], v[90:91], v[88:89]
    v_pk_mul_f32 v[92:93], v[92:93], v[88:89]
    v_cvt_pk_bf16_f32 v90, v90, v91
    v_cvt_pk_bf16_f32 v92, v92, v93
    v_dot2c_f32_bf16 v94, v90, v96
    v_dot2c_f32_bf16 v95, v92, v96
    v_lshlrev_b32 v88, 16, v68
    v_and_b32 v89, 0xffff0000, v68
    v_lshlrev_b32 v90, 16, v20
    v_and_b32 v91, 0xffff0000, v20
    v_lshlrev_b32 v92, 16, v24
    v_and_b32 v93, 0xffff0000, v24
    v_pk_mul_f32 v[90:91], v[90:91], v[88:89]
    v_pk_mul_f32 v[92:93], v[92:93], v[88:89]
    v_cvt_pk_bf16_f32 v90, v90, v91
    v_cvt_pk_bf16_f32 v92, v92, v93
    v_dot2c_f32_bf16 v94, v90, v96
    v_dot2c_f32_bf16 v95, v92, v96
    v_lshlrev_b32 v88, 16, v69
    v_and_b32 v89, 0xffff0000, v69
    v_lshlrev_b32 v90, 16, v21
    v_and_b32 v91, 0xffff0000, v21
    v_lshlrev_b32 v92, 16, v25
    v_and_b32 v93, 0xffff0000, v25
    v_pk_mul_f32 v[90:91], v[90:91], v[88:89]
    v_pk_mul_f32 v[92:93], v[92:93], v[88:89]
    v_cvt_pk_bf16_f32 v90, v90, v91
    v_cvt_pk_bf16_f32 v92, v92, v93
    v_dot2c_f32_bf16 v94, v90, v96
    v_dot2c_f32_bf16 v95, v92, v96
    v_lshlrev_b32 v88, 16, v70
    v_and_b32 v89, 0xffff0000, v70
    v_lshlrev_b32 v90, 16, v22
    v_and_b32 v91, 0xffff0000, v22
    v_lshlrev_b32 v92, 16, v26
    v_and_b32 v93, 0xffff0000, v26
    v_pk_mul_f32 v[90:91], v[90:91], v[88:89]
    v_pk_mul_f32 v[92:93], v[92:93], v[88:89]
    v_cvt_pk_bf16_f32 v90, v90, v91
    v_cvt_pk_bf16_f32 v92, v92, v93
    v_dot2c_f32_bf16 v94, v90, v96
    v_dot2c_f32_bf16 v95, v92, v96
    v_lshlrev_b32 v88, 16, v71
    v_and_b32 v89, 0xffff0000, v71
    v_lshlrev_b32 v90, 16, v23
    v_and_b32 v91, 0xffff0000, v23
    v_lshlrev_b32 v92, 16, v27
    v_and_b32 v93, 0xffff0000, v27
    v_pk_mul_f32 v[90:91], v[90:91], v[88:89]
    v_pk_mul_f32 v[92:93], v[92:93], v[88:89]
    v_cvt_pk_bf16_f32 v90, v90, v91
    v_cvt_pk_bf16_f32 v92, v92, v93
    v_dot2c_f32_bf16 v94, v90, v96
    v_dot2c_f32_bf16 v95, v92, v96
    v_lshlrev_b32 v88, 16, v72
    v_and_b32 v89, 0xffff0000, v72
    v_lshlrev_b32 v90, 16, v28
    v_and_b32 v91, 0xffff0000, v28
    v_lshlrev_b32 v92, 16, v32
    v_and_b32 v93, 0xffff0000, v32
    v_pk_mul_f32 v[90:91], v[90:91], v[88:89]
    v_pk_mul_f32 v[92:93], v[92:93], v[88:89]
    v_cvt_pk_bf16_f32 v90, v90, v91
    v_cvt_pk_bf16_f32 v92, v92, v93
    v_dot2c_f32_bf16 v94, v90, v96
    v_dot2c_f32_bf16 v95, v92, v96
    v_lshlrev_b32 v88, 16, v73
    v_and_b32 v89, 0xffff0000, v73
    v_lshlrev_b32 v90, 16, v29
    v_and_b32 v91, 0xffff0000, v29
    v_lshlrev_b32 v92, 16, v33
    v_and_b32 v93, 0xffff0000, v33
    v_pk_mul_f32 v[90:91], v[90:91], v[88:89]
    v_pk_mul_f32 v[92:93], v[92:93], v[88:89]
    v_cvt_pk_bf16_f32 v90, v90, v91
    v_cvt_pk_bf16_f32 v92, v92, v93
    v_dot2c_f32_bf16 v94, v90, v96
    v_dot2c_f32_bf16 v95, v92, v96
    v_lshlrev_b32 v88, 16, v74
    v_and_b32 v89, 0xffff0000, v74
    v_lshlrev_b32 v90, 16, v30
    v_and_b32 v91, 0xffff0000, v30
    v_lshlrev_b32 v92, 16, v34
    v_and_b32 v93, 0xffff0000, v34
    v_pk_mul_f32 v[90:91], v[90:91], v[88:89]
    v_pk_mul_f32 v[92:93], v[92:93], v[88:89]
    v_cvt_pk_bf16_f32 v90, v90, v91
    v_cvt_pk_bf16_f32 v92, v92, v93
    v_dot2c_f32_bf16 v94, v90, v96
    v_dot2c_f32_bf16 v95, v92, v96
    v_lshlrev_b32 v88, 16, v75
    v_and_b32 v89, 0xffff0000, v75
    v_lshlrev_b32 v90, 16, v31
    v_and_b32 v91, 0xffff0000, v31
    v_lshlrev_b32 v92, 16, v35
    v_and_b32 v93, 0xffff0000, v35
    v_pk_mul_f32 v[90:91], v[90:91], v[88:89]
    v_pk_mul_f32 v[92:93], v[92:93], v[88:89]
    v_cvt_pk_bf16_f32 v90, v90, v91
    v_cvt_pk_bf16_f32 v92, v92, v93
    v_dot2c_f32_bf16 v94, v90, v96
    v_dot2c_f32_bf16 v95, v92, v96
    v_lshlrev_b32 v88, 16, v76
    v_and_b32 v89, 0xffff0000, v76
    v_lshlrev_b32 v90, 16, v36
    v_and_b32 v91, 0xffff0000, v36
    v_lshlrev_b32 v92, 16, v40
    v_and_b32 v93, 0xffff0000, v40
    v_pk_mul_f32 v[90:91], v[90:91], v[88:89]
    v_pk_mul_f32 v[92:93], v[92:93], v[88:89]
    v_cvt_pk_bf16_f32 v90, v90, v91
    v_cvt_pk_bf16_f32 v92, v92, v93
    v_dot2c_f32_bf16 v94, v90, v96
    v_dot2c_f32_bf16 v95, v92, v96
    v_lshlrev_b32 v88, 16, v77
    v_and_b32 v89, 0xffff0000, v77
    v_lshlrev_b32 v90, 16, v37
    v_and_b32 v91, 0xffff0000, v37
    v_lshlrev_b32 v92, 16, v41
    v_and_b32 v93, 0xffff0000, v41
    v_pk_mul_f32 v[90:91], v[90:91], v[88:89]
    v_pk_mul_f32 v[92:93], v[92:93], v[88:89]
    v_cvt_pk_bf16_f32 v90, v90, v91
    v_cvt_pk_bf16_f32 v92, v92, v93
    v_dot2c_f32_bf16 v94, v90, v96
    v_dot2c_f32_bf16 v95, v92, v96
    v_lshlrev_b32 v88, 16, v78
    v_and_b32 v89, 0xffff0000, v78
    v_lshlrev_b32 v90, 16, v38
    v_and_b32 v91, 0xffff0000, v38
    v_lshlrev_b32 v92, 16, v42
    v_and_b32 v93, 0xffff0000, v42
    v_pk_mul_f32 v[90:91], v[90:91], v[88:89]
    v_pk_mul_f32 v[92:93], v[92:93], v[88:89]
    v_cvt_pk_bf16_f32 v90, v90, v91
    v_cvt_pk_bf16_f32 v92, v92, v93
    v_dot2c_f32_bf16 v94, v90, v96
    v_dot2c_f32_bf16 v95, v92, v96
    v_lshlrev_b32 v88, 16, v79
    v_and_b32 v89, 0xffff0000, v79
    v_lshlrev_b32 v90, 16, v39
    v_and_b32 v91, 0xffff0000, v39
    v_lshlrev_b32 v92, 16, v43
    v_and_b32 v93, 0xffff0000, v43
    v_pk_mul_f32 v[90:91], v[90:91], v[88:89]
    v_pk_mul_f32 v[92:93], v[92:93], v[88:89]
    v_cvt_pk_bf16_f32 v90, v90, v91
    v_cvt_pk_bf16_f32 v92, v92, v93
    v_dot2c_f32_bf16 v94, v90, v96
    v_dot2c_f32_bf16 v95, v92, v96
    v_lshlrev_b32 v88, 16, v80
    v_and_b32 v89, 0xffff0000, v80
    v_lshlrev_b32 v90, 16, v44
    v_and_b32 v91, 0xffff0000, v44
    v_lshlrev_b32 v92, 16, v48
    v_and_b32 v93, 0xffff0000, v48
    v_pk_mul_f32 v[90:91], v[90:91], v[88:89]
    v_pk_mul_f32 v[92:93], v[92:93], v[88:89]
    v_cvt_pk_bf16_f32 v90, v90, v91
    v_cvt_pk_bf16_f32 v92, v92, v93
    v_dot2c_f32_bf16 v94, v90, v96
    v_dot2c_f32_bf16 v95, v92, v96
    v_lshlrev_b32 v88, 16, v81
    v_and_b32 v89, 0xffff0000, v81
    v_lshlrev_b32 v90, 16, v45
    v_and_b32 v91, 0xffff0000, v45
    v_lshlrev_b32 v92, 16, v49
    v_and_b32 v93, 0xffff0000, v49
    v_pk_mul_f32 v[90:91], v[90:91], v[88:89]
    v_pk_mul_f32 v[92:93], v[92:93], v[88:89]
    v_cvt_pk_bf16_f32 v90, v90, v91
    v_cvt_pk_bf16_f32 v92, v92, v93
    v_dot2c_f32_bf16 v94, v90, v96
    v_dot2c_f32_bf16 v95, v92, v96
    v_lshlrev_b32 v88, 16, v82
    v_and_b32 v89, 0xffff0000, v82
    v_lshlrev_b32 v90, 16, v46
    v_and_b32 v91, 0xffff0000, v46
    v_lshlrev_b32 v92, 16, v50
    v_and_b32 v93, 0xffff0000, v50
    v_pk_mul_f32 v[90:91], v[90:91], v[88:89]
    v_pk_mul_f32 v[92:93], v[92:93], v[88:89]
    v_cvt_pk_bf16_f32 v90, v90, v91
    v_cvt_pk_bf16_f32 v92, v92, v93
    v_dot2c_f32_bf16 v94, v90, v96
    v_dot2c_f32_bf16 v95, v92, v96
    v_lshlrev_b32 v88, 16, v83
    v_and_b32 v89, 0xffff0000, v83
    v_lshlrev_b32 v90, 16, v47
    v_and_b32 v91, 0xffff0000, v47
    v_lshlrev_b32 v92, 16, v51
    v_and_b32 v93, 0xffff0000, v51
    v_pk_mul_f32 v[90:91], v[90:91], v[88:89]
    v_pk_mul_f32 v[92:93], v[92:93], v[88:89]
    v_cvt_pk_bf16_f32 v90, v90, v91
    v_cvt_pk_bf16_f32 v92, v92, v93
    v_dot2c_f32_bf16 v94, v90, v96
    v_dot2c_f32_bf16 v95, v92, v96
    v_lshlrev_b32 v88, 16, v84
    v_and_b32 v89, 0xffff0000, v84
    v_lshlrev_b32 v90, 16, v52
    v_and_b32 v91, 0xffff0000, v52
    v_lshlrev_b32 v92, 16, v56
    v_and_b32 v93, 0xffff0000, v56
    v_pk_mul_f32 v[90:91], v[90:91], v[88:89]
    v_pk_mul_f32 v[92:93], v[92:93], v[88:89]
    v_cvt_pk_bf16_f32 v90, v90, v91
    v_cvt_pk_bf16_f32 v92, v92, v93
    v_dot2c_f32_bf16 v94, v90, v96
    v_dot2c_f32_bf16 v95, v92, v96
    v_lshlrev_b32 v88, 16, v85
    v_and_b32 v89, 0xffff0000, v85
    v_lshlrev_b32 v90, 16, v53
    v_and_b32 v91, 0xffff0000, v53
    v_lshlrev_b32 v92, 16, v57
    v_and_b32 v93, 0xffff0000, v57
    v_pk_mul_f32 v[90:91], v[90:91], v[88:89]
    v_pk_mul_f32 v[92:93], v[92:93], v[88:89]
    v_cvt_pk_bf16_f32 v90, v90, v91
    v_cvt_pk_bf16_f32 v92, v92, v93
    v_dot2c_f32_bf16 v94, v90, v96
    v_dot2c_f32_bf16 v95, v92, v96
    v_lshlrev_b32 v88, 16, v86
    v_and_b32 v89, 0xffff0000, v86
    v_lshlrev_b32 v90, 16, v54
    v_and_b32 v91, 0xffff0000, v54
    v_lshlrev_b32 v92, 16, v58
    v_and_b32 v93, 0xffff0000, v58
    v_pk_mul_f32 v[90:91], v[90:91], v[88:89]
    v_pk_mul_f32 v[92:93], v[92:93], v[88:89]
    v_cvt_pk_bf16_f32 v90, v90, v91
    v_cvt_pk_bf16_f32 v92, v92, v93
    v_dot2c_f32_bf16 v94, v90, v96
    v_dot2c_f32_bf16 v95, v92, v96
    v_lshlrev_b32 v88, 16, v87
    v_and_b32 v89, 0xffff0000, v87
    v_lshlrev_b32 v90, 16, v55
    v_and_b32 v91, 0xffff0000, v55
    v_lshlrev_b32 v92, 16, v59
    v_and_b32 v93, 0xffff0000, v59
    v_pk_mul_f32 v[90:91], v[90:91], v[88:89]
    v_pk_mul_f32 v[92:93], v[92:93], v[88:89]
    v_cvt_pk_bf16_f32 v90, v90, v91
    v_cvt_pk_bf16_f32 v92, v92, v93
    v_dot2c_f32_bf16 v94, v90, v96
    v_dot2c_f32_bf16 v95, v92, v96
    v_and_b32 v88, 1, v98
    v_cmp_eq_u32 vcc, 1, v88
    v_add_u32 v99, v99, v88
    s_nop 1
    v_add_f32_dpp v94, v94, v94 quad_perm:[1,0,3,2] row_mask:0xf bank_mask:0xf
    v_add_f32_dpp v95, v95, v95 quad_perm:[1,0,3,2] row_mask:0xf bank_mask:0xf
    s_nop 0
    v_add_f32_dpp v94, v94, v94 quad_perm:[2,3,0,1] row_mask:0xf bank_mask:0xf
    v_add_f32_dpp v95, v95, v95 quad_perm:[2,3,0,1] row_mask:0xf bank_mask:0xf
    s_nop 0
    v_add_f32_dpp v94, v94, v94 row_half_mirror row_mask:0xf bank_mask:0xf
    v_add_f32_dpp v95, v95, v95 row_half_mirror row_mask:0xf bank_mask:0xf
    s_nop 0
    v_cndmask_b32 v94, v94, v95, vcc
    v_cvt_pk_bf16_f32 v94, v94, v94
    v_lshlrev_b32 v94, 16, v94
    v_mul_f32 v94, 0xbfb8aa3b, v94
    v_exp_f32 v94, v94
    s_lshl_b32 s85, s3, 6
    v_add_f32 v94, 1.0, v94
    v_rcp_f32 v94, v94
    v_lshl_add_u32 v99, v99, 2, s85
    v_cvt_pk_bf16_f32 v94, v94, v94
    v_lshlrev_b32 v94, 16, v94
    v_sub_f32 v95, 1.0, v94
    v_cvt_pk_bf16_f32 v95, v95, v95
    v_lshlrev_b32 v95, 16, v95
    v_max_f32 v95, 0x2b800000, v95
    v_rcp_f32 v95, v95
    v_cmp_gt_u32 vcc, 196, v0
    v_mul_f32 v95, v94, v95
    v_min_u32 v95, -2, v95
    ds_write_b32 v99, v94
    ds_write_b32 v99, v95 offset:256
    s_waitcnt lgkmcnt(0)
    s_barrier
    ds_read_b128 v[88:91], v167
    s_cmp_lg_u32 s3, 0
    s_waitcnt lgkmcnt(0)
    s_cbranch_scc1 L_h3
    buffer_store_dwordx4 v[88:91], v167, s[24:27], s80 offen sc1
L_h3:
    s_add_u32 s87, s83, 0
    s_and_b32 s87, s87, 3
    s_add_u32 s87, s87, s84
    s_mul_i32 s85, s87, 28
    v_add_u32 v164, s85, v160
    v_and_b32 v165, 0xffffffc0, v164
    v_add_u32 v164, v164, v165
    v_mul_u32_u24 v164, 896, v164
    v_lshl_add_u32 v164, v161, 7, v164
    v_cndmask_b32 v164, v155, v164, vcc
    s_mul_i32 s85, s82, 802816
    s_add_u32 s85, s85, 57344
    buffer_load_dword v173, v164, s[16:19], s85 offen
    s_mul_i32 s85, s81, 57344
    s_add_u32 s85, s85, 11665408
    buffer_store_dwordx4 v[156:159], v151, s[24:27], s85 offen sc1
    s_add_u32 s85, s85, 4096
    buffer_store_dwordx4 v[156:159], v151, s[24:27], s85 offen sc1
    s_add_u32 s85, s85, 4096
    buffer_store_dwordx4 v[156:159], v151, s[24:27], s85 offen sc1
    s_add_u32 s85, s85, 4096
    buffer_store_dwordx4 v[156:159], v151, s[24:27], s85 offen sc1
    s_add_u32 s85, s85, 4096
    buffer_store_dwordx4 v[156:159], v151, s[24:27], s85 offen sc1
    s_add_u32 s85, s85, 4096
    buffer_store_dwordx4 v[156:159], v151, s[24:27], s85 offen sc1
    s_add_u32 s85, s85, 4096
    buffer_store_dwordx4 v[156:159], v151, s[24:27], s85 offen sc1
    s_add_u32 s85, s85, 4096
    buffer_store_dwordx4 v[156:159], v151, s[24:27], s85 offen sc1
    s_add_u32 s85, s85, 4096
    buffer_store_dwordx4 v[156:159], v151, s[24:27], s85 offen sc1
    s_add_u32 s85, s85, 4096
    buffer_store_dwordx4 v[156:159], v151, s[24:27], s85 offen sc1
    s_add_u32 s85, s85, 4096
    buffer_store_dwordx4 v[156:159], v151, s[24:27], s85 offen sc1
    s_add_u32 s85, s85, 4096
    buffer_store_dwordx4 v[156:159], v151, s[24:27], s85 offen sc1
    s_add_u32 s85, s85, 4096
    buffer_store_dwordx4 v[156:159], v151, s[24:27], s85 offen sc1
    s_add_u32 s85, s85, 4096
    buffer_store_dwordx4 v[156:159], v151, s[24:27], s85 offen sc1
    s_add_u32 s85, s85, 4096
    s_add_u32 s87, s83, 1
    s_and_b32 s87, s87, 3
    s_add_u32 s87, s87, s84
    s_mul_i32 s85, s87, 28
    v_add_u32 v164, s85, v160
    v_and_b32 v165, 0xffffffc0, v164
    v_add_u32 v164, v164, v165
    v_mul_u32_u24 v164, 896, v164
    v_lshl_add_u32 v164, v161, 7, v164
    v_cndmask_b32 v164, v155, v164, vcc
    s_mul_i32 s85, s82, 802816
    s_add_u32 s85, s85, 57344
    buffer_load_dword v174, v164, s[16:19], s85 offen
    v_lshrrev_b32 v164, 3, v0
    v_min_u32 v164, 27, v164
    v_lshlrev_b32 v164, 9, v164
    v_and_b32 v165, 7, v0
    v_lshl_add_u32 v164, v165, 4, v164
    s_waitcnt vmcnt(0)
    s_barrier
    buffer_store_dwordx4 v[156:159], v164, s[24:27], s86 offen offset:384 sc1
    s_waitcnt vmcnt(0) lgkmcnt(0)
L_end:
    s_endpgm
.section .rodata,"a"
.p2align 6
.amdhsa_kernel gated_mix__ssm_conv_s5__dense_activation_relu__prompt_kernel
  .amdhsa_next_free_vgpr 512
  .amdhsa_next_free_sgpr 102
  .amdhsa_accum_offset 256
  .amdhsa_group_segment_fixed_size 0
  .amdhsa_kernarg_size 128
  .amdhsa_user_sgpr_count 2
  .amdhsa_user_sgpr_kernarg_segment_ptr 1
  .amdhsa_system_sgpr_workgroup_id_x 1
.end_amdhsa_kernel
```
